```python
import torch

def _softmax(x, axis=-1):
    return torch.softmax(x, dim=axis)

def _gelu(x):
    return torch.nn.functional.gelu(x, approximate='tanh')

def _silu(x):
    return torch.nn.functional.silu(x)

def _sigmoid(x):
    return torch.sigmoid(x)

def _layernorm(x, axis=-1, eps=1e-05):
    m = x.mean(dim=axis, keepdim=True)
    v = x.var(dim=axis, keepdim=True, unbiased=False)
    return (x - m) / torch.sqrt(v + eps)

def _scatter_add(tgt, idx, src, axis=0):
    return tgt.clone().index_add_(axis, idx, src)

def _segment_sum(src, seg, n):
    out = torch.zeros((n,) + src.shape[1:], dtype=src.dtype)
    return out.index_add_(0, seg, src)

def _pad(x, pw):
    flat = tuple((v for pair in reversed(pw) for v in pair))
    return torch.nn.functional.pad(x, flat)
kernel_name = 'standalone__molecular_angular_painn__graph'

def setup_inputs():

    _w = lambda a: (lambda t: t.to(torch.bfloat16) if t.is_floating_point() else t)(torch.as_tensor(a))
    N, deg, D = (12500, 32, 128)
    n_rbf = max(4, 4)
    E = N * deg
    cutoff = 5.0
    freqs = (torch.arange(1, n_rbf + 1) * torch.pi / cutoff).to(float)
    return {'sv': _w((lambda *s: torch.randn(*s, dtype=torch.bfloat16) * 0.4)(N, 4, D) * 0.3), 'pos': _w((lambda *s: torch.randn(*s, dtype=torch.bfloat16) * 3.2)(N, 3) * 1.2), 'src': _w((lambda lo, hi, *s: torch.randint(lo, hi, s))(0, N, E).to(torch.int64)), 'dst': _w((lambda lo, hi, *s: torch.randint(lo, hi, s))(0, N, E).to(torch.int64)), 'freqs': _w(freqs), 'w_phi1': _w((lambda *s: torch.randn(*s, dtype=torch.bfloat16) * 3.2)(D, D) / D ** 0.5), 'w_phi2': _w((lambda *s: torch.randn(*s, dtype=torch.bfloat16) * 3.2)(D, 3 * D) / D ** 0.5), 'w_rbf': _w((lambda *s: torch.randn(*s, dtype=torch.bfloat16) * 3.2)(n_rbf, 3 * D) / n_rbf ** 0.5)}

def reference(sv, pos, src, dst, freqs, w_phi1, w_phi2, w_rbf):
    N, _, D = sv.shape
    E = src.shape[0]
    PI, cutoff = (3.141592653589793, 5.0)
    s, v = (sv[:, 0, :].clone(), sv[:, 1:, :].clone())
    r_vec = pos[src] - pos[dst]
    d = torch.sqrt((r_vec * r_vec).sum(-1) + 1e-08)
    r_hat = r_vec / d[:, None]
    rbf = torch.sin(d[:, None] * freqs[None, :]) / d[:, None]
    fcut = 0.5 * (torch.cos(PI * d / cutoff) + 1.0)
    fcut = torch.where(d < cutoff, fcut, 0.0 * d)
    Wf = rbf @ w_rbf * fcut[:, None]
    phi = (_silu(s @ w_phi1) @ w_phi2)[src]
    m = phi * Wf
    m_s, m_vv, m_vr = (m[:, :D].clone(), m[:, D:2 * D].clone(), m[:, 2 * D:].clone())
    ds = _segment_sum(m_s, dst, N)
    dv_e = m_vv[:, None, :] * v[src] + m_vr[:, None, :] * r_hat[:, :, None]
    dv = _segment_sum(dv_e.reshape(E, 3 * D), dst, N).reshape(N, 3, D)
    return sv + torch.concatenate([ds[:, None, :], dv], axis=1)
```

```asm
; @launch kernel=painn_k1_kernel grid=(246,1,1) block=(512,1,1) lds=140288
; @launch kernel=painn_k2_kernel grid=(256,1,1) block=(1024,1,1) lds=141312
.amdgcn_target "amdgcn-amd-amdhsa--gfx950"
.text
.globl painn_k1_kernel
.p2align 8
.type painn_k1_kernel,@function
painn_k1_kernel:
s_cmp_ge_u32 s2, 246
s_cbranch_scc1 K1_END
s_load_dwordx8 s[8:15], s[0:1], 0
s_load_dwordx4 s[16:19], s[0:1], 40
s_load_dwordx2 s[20:21], s[0:1], 80
v_lshrrev_b32 v1, 6, v0
s_nop 0
v_readfirstlane_b32 s3, v1
v_and_b32 v1, 63, v0
s_cmp_lt_u32 s2, 50
s_cbranch_scc1 K1_EDGE
s_sub_u32 s7, s2, 50
s_cmp_ge_u32 s3, 4
s_cbranch_scc1 K1_HELP
s_waitcnt lgkmcnt(0)
s_mov_b32 s24, s8
s_mov_b32 s25, s9
s_mov_b32 s26, 12800000
s_mov_b32 s27, 0x20000
s_lshl_b32 s6, s7, 6
s_lshl_b32 s57, s3, 4
s_add_u32 s6, s6, s57
s_mov_b32 s48, s20
s_mov_b32 s49, s21
s_mov_b32 s50, 16000000
s_mov_b32 s51, 0x20000
v_and_b32 v2, 15, v1
v_lshrrev_b32 v3, 4, v1
v_add_u32 v4, s6, v2
v_lshlrev_b32 v4, 10, v4
v_lshl_add_u32 v4, v3, 4, v4
buffer_load_dwordx4 v[16:19], v4, s[24:27], 0 offen offset:0
buffer_load_dwordx4 v[20:23], v4, s[24:27], 0 offen offset:64
buffer_load_dwordx4 v[24:27], v4, s[24:27], 0 offen offset:128
buffer_load_dwordx4 v[28:31], v4, s[24:27], 0 offen offset:192
v_lshlrev_b32 v5, 2, v3
v_add_u32 v5, s6, v5
v_lshlrev_b32 v5, 10, v5
v_lshl_add_u32 v5, v2, 4, v5
v_lshrrev_b32 v8, 3, v2
v_lshlrev_b32 v9, 4, v1
v_add_u32 v10, 98304, v9
v_add_u32 v11, 32768, v9
v_add_u32 v12, 65536, v9
s_barrier
s_waitcnt vmcnt(0)
ds_read_b128 v[48:51], v10 offset:0
ds_read_b128 v[52:55], v10 offset:1024
ds_read_b128 v[56:59], v10 offset:2048
ds_read_b128 v[60:63], v10 offset:3072
s_waitcnt lgkmcnt(3)
v_mfma_f32_16x16x32_bf16 v[160:163], v[48:51], v[16:19], 0
ds_read_b128 v[48:51], v10 offset:4096
s_waitcnt lgkmcnt(3)
v_mfma_f32_16x16x32_bf16 v[160:163], v[52:55], v[20:23], v[160:163]
ds_read_b128 v[52:55], v10 offset:5120
s_waitcnt lgkmcnt(3)
v_mfma_f32_16x16x32_bf16 v[160:163], v[56:59], v[24:27], v[160:163]
ds_read_b128 v[56:59], v10 offset:6144
s_waitcnt lgkmcnt(3)
v_mfma_f32_16x16x32_bf16 v[160:163], v[60:63], v[28:31], v[160:163]
ds_read_b128 v[60:63], v10 offset:7168
s_waitcnt lgkmcnt(3)
v_mfma_f32_16x16x32_bf16 v[164:167], v[48:51], v[16:19], 0
ds_read_b128 v[48:51], v10 offset:8192
s_waitcnt lgkmcnt(3)
v_mfma_f32_16x16x32_bf16 v[164:167], v[52:55], v[20:23], v[164:167]
ds_read_b128 v[52:55], v10 offset:9216
s_waitcnt lgkmcnt(3)
v_mfma_f32_16x16x32_bf16 v[164:167], v[56:59], v[24:27], v[164:167]
ds_read_b128 v[56:59], v10 offset:10240
s_waitcnt lgkmcnt(3)
v_mfma_f32_16x16x32_bf16 v[164:167], v[60:63], v[28:31], v[164:167]
ds_read_b128 v[60:63], v10 offset:11264
s_waitcnt lgkmcnt(3)
v_mfma_f32_16x16x32_bf16 v[168:171], v[48:51], v[16:19], 0
ds_read_b128 v[48:51], v10 offset:12288
s_waitcnt lgkmcnt(3)
v_mfma_f32_16x16x32_bf16 v[168:171], v[52:55], v[20:23], v[168:171]
ds_read_b128 v[52:55], v10 offset:13312
s_waitcnt lgkmcnt(3)
v_mfma_f32_16x16x32_bf16 v[168:171], v[56:59], v[24:27], v[168:171]
ds_read_b128 v[56:59], v10 offset:14336
s_waitcnt lgkmcnt(3)
v_mfma_f32_16x16x32_bf16 v[168:171], v[60:63], v[28:31], v[168:171]
ds_read_b128 v[60:63], v10 offset:15360
s_waitcnt lgkmcnt(3)
v_mfma_f32_16x16x32_bf16 v[172:175], v[48:51], v[16:19], 0
ds_read_b128 v[48:51], v10 offset:16384
s_waitcnt lgkmcnt(3)
v_mfma_f32_16x16x32_bf16 v[172:175], v[52:55], v[20:23], v[172:175]
ds_read_b128 v[52:55], v10 offset:17408
s_waitcnt lgkmcnt(3)
v_mfma_f32_16x16x32_bf16 v[172:175], v[56:59], v[24:27], v[172:175]
ds_read_b128 v[56:59], v10 offset:18432
s_waitcnt lgkmcnt(3)
v_mfma_f32_16x16x32_bf16 v[172:175], v[60:63], v[28:31], v[172:175]
ds_read_b128 v[60:63], v10 offset:19456
s_waitcnt lgkmcnt(3)
v_mfma_f32_16x16x32_bf16 v[176:179], v[48:51], v[16:19], 0
ds_read_b128 v[48:51], v10 offset:20480
s_waitcnt lgkmcnt(3)
v_mfma_f32_16x16x32_bf16 v[176:179], v[52:55], v[20:23], v[176:179]
ds_read_b128 v[52:55], v10 offset:21504
s_waitcnt lgkmcnt(3)
v_mfma_f32_16x16x32_bf16 v[176:179], v[56:59], v[24:27], v[176:179]
ds_read_b128 v[56:59], v10 offset:22528
s_waitcnt lgkmcnt(3)
v_mfma_f32_16x16x32_bf16 v[176:179], v[60:63], v[28:31], v[176:179]
ds_read_b128 v[60:63], v10 offset:23552
s_waitcnt lgkmcnt(3)
v_mfma_f32_16x16x32_bf16 v[180:183], v[48:51], v[16:19], 0
ds_read_b128 v[48:51], v10 offset:24576
s_waitcnt lgkmcnt(3)
v_mfma_f32_16x16x32_bf16 v[180:183], v[52:55], v[20:23], v[180:183]
ds_read_b128 v[52:55], v10 offset:25600
s_waitcnt lgkmcnt(3)
v_mfma_f32_16x16x32_bf16 v[180:183], v[56:59], v[24:27], v[180:183]
ds_read_b128 v[56:59], v10 offset:26624
s_waitcnt lgkmcnt(3)
v_mfma_f32_16x16x32_bf16 v[180:183], v[60:63], v[28:31], v[180:183]
ds_read_b128 v[60:63], v10 offset:27648
s_waitcnt lgkmcnt(3)
v_mfma_f32_16x16x32_bf16 v[184:187], v[48:51], v[16:19], 0
ds_read_b128 v[48:51], v10 offset:28672
s_waitcnt lgkmcnt(3)
v_mfma_f32_16x16x32_bf16 v[184:187], v[52:55], v[20:23], v[184:187]
ds_read_b128 v[52:55], v10 offset:29696
s_waitcnt lgkmcnt(3)
v_mfma_f32_16x16x32_bf16 v[184:187], v[56:59], v[24:27], v[184:187]
ds_read_b128 v[56:59], v10 offset:30720
s_waitcnt lgkmcnt(3)
v_mfma_f32_16x16x32_bf16 v[184:187], v[60:63], v[28:31], v[184:187]
ds_read_b128 v[60:63], v10 offset:31744
s_waitcnt lgkmcnt(3)
v_mfma_f32_16x16x32_bf16 v[188:191], v[48:51], v[16:19], 0
s_waitcnt lgkmcnt(2)
v_mfma_f32_16x16x32_bf16 v[188:191], v[52:55], v[20:23], v[188:191]
s_waitcnt lgkmcnt(1)
v_mfma_f32_16x16x32_bf16 v[188:191], v[56:59], v[24:27], v[188:191]
s_waitcnt lgkmcnt(0)
v_mfma_f32_16x16x32_bf16 v[188:191], v[60:63], v[28:31], v[188:191]
s_mov_b32 s60, 0xbfb8aa3b
s_mov_b32 s61, 0xffff0000
v_cvt_pk_bf16_f32 v48, v160, v161
v_lshlrev_b32 v160, 16, v48
v_and_b32 v161, s61, v48
v_mul_f32 v49, s60, v160
v_mul_f32 v50, s60, v161
v_exp_f32 v49, v49
v_exp_f32 v50, v50
v_add_f32 v49, 1.0, v49
v_add_f32 v50, 1.0, v50
v_rcp_f32 v49, v49
v_rcp_f32 v50, v50
v_mul_f32 v160, v160, v49
v_mul_f32 v161, v161, v50
v_cvt_pk_bf16_f32 v16, v160, v161
v_cvt_pk_bf16_f32 v54, v162, v163
v_lshlrev_b32 v162, 16, v54
v_and_b32 v163, s61, v54
v_mul_f32 v55, s60, v162
v_mul_f32 v56, s60, v163
v_exp_f32 v55, v55
v_exp_f32 v56, v56
v_add_f32 v55, 1.0, v55
v_add_f32 v56, 1.0, v56
v_rcp_f32 v55, v55
v_rcp_f32 v56, v56
v_mul_f32 v162, v162, v55
v_mul_f32 v163, v163, v56
v_cvt_pk_bf16_f32 v17, v162, v163
v_cvt_pk_bf16_f32 v48, v164, v165
v_lshlrev_b32 v164, 16, v48
v_and_b32 v165, s61, v48
v_mul_f32 v49, s60, v164
v_mul_f32 v50, s60, v165
v_exp_f32 v49, v49
v_exp_f32 v50, v50
v_add_f32 v49, 1.0, v49
v_add_f32 v50, 1.0, v50
v_rcp_f32 v49, v49
v_rcp_f32 v50, v50
v_mul_f32 v164, v164, v49
v_mul_f32 v165, v165, v50
v_cvt_pk_bf16_f32 v18, v164, v165
v_cvt_pk_bf16_f32 v54, v166, v167
v_lshlrev_b32 v166, 16, v54
v_and_b32 v167, s61, v54
v_mul_f32 v55, s60, v166
v_mul_f32 v56, s60, v167
v_exp_f32 v55, v55
v_exp_f32 v56, v56
v_add_f32 v55, 1.0, v55
v_add_f32 v56, 1.0, v56
v_rcp_f32 v55, v55
v_rcp_f32 v56, v56
v_mul_f32 v166, v166, v55
v_mul_f32 v167, v167, v56
v_cvt_pk_bf16_f32 v19, v166, v167
v_cvt_pk_bf16_f32 v48, v168, v169
v_lshlrev_b32 v168, 16, v48
v_and_b32 v169, s61, v48
v_mul_f32 v49, s60, v168
v_mul_f32 v50, s60, v169
v_exp_f32 v49, v49
v_exp_f32 v50, v50
v_add_f32 v49, 1.0, v49
v_add_f32 v50, 1.0, v50
v_rcp_f32 v49, v49
v_rcp_f32 v50, v50
v_mul_f32 v168, v168, v49
v_mul_f32 v169, v169, v50
v_cvt_pk_bf16_f32 v20, v168, v169
v_cvt_pk_bf16_f32 v54, v170, v171
v_lshlrev_b32 v170, 16, v54
v_and_b32 v171, s61, v54
v_mul_f32 v55, s60, v170
v_mul_f32 v56, s60, v171
v_exp_f32 v55, v55
v_exp_f32 v56, v56
v_add_f32 v55, 1.0, v55
v_add_f32 v56, 1.0, v56
v_rcp_f32 v55, v55
v_rcp_f32 v56, v56
v_mul_f32 v170, v170, v55
v_mul_f32 v171, v171, v56
v_cvt_pk_bf16_f32 v21, v170, v171
v_cvt_pk_bf16_f32 v48, v172, v173
v_lshlrev_b32 v172, 16, v48
v_and_b32 v173, s61, v48
v_mul_f32 v49, s60, v172
v_mul_f32 v50, s60, v173
v_exp_f32 v49, v49
v_exp_f32 v50, v50
v_add_f32 v49, 1.0, v49
v_add_f32 v50, 1.0, v50
v_rcp_f32 v49, v49
v_rcp_f32 v50, v50
v_mul_f32 v172, v172, v49
v_mul_f32 v173, v173, v50
v_cvt_pk_bf16_f32 v22, v172, v173
v_cvt_pk_bf16_f32 v54, v174, v175
v_lshlrev_b32 v174, 16, v54
v_and_b32 v175, s61, v54
v_mul_f32 v55, s60, v174
v_mul_f32 v56, s60, v175
v_exp_f32 v55, v55
v_exp_f32 v56, v56
v_add_f32 v55, 1.0, v55
v_add_f32 v56, 1.0, v56
v_rcp_f32 v55, v55
v_rcp_f32 v56, v56
v_mul_f32 v174, v174, v55
v_mul_f32 v175, v175, v56
v_cvt_pk_bf16_f32 v23, v174, v175
v_cvt_pk_bf16_f32 v48, v176, v177
v_lshlrev_b32 v176, 16, v48
v_and_b32 v177, s61, v48
v_mul_f32 v49, s60, v176
v_mul_f32 v50, s60, v177
v_exp_f32 v49, v49
v_exp_f32 v50, v50
v_add_f32 v49, 1.0, v49
v_add_f32 v50, 1.0, v50
v_rcp_f32 v49, v49
v_rcp_f32 v50, v50
v_mul_f32 v176, v176, v49
v_mul_f32 v177, v177, v50
v_cvt_pk_bf16_f32 v24, v176, v177
v_cvt_pk_bf16_f32 v54, v178, v179
v_lshlrev_b32 v178, 16, v54
v_and_b32 v179, s61, v54
v_mul_f32 v55, s60, v178
v_mul_f32 v56, s60, v179
v_exp_f32 v55, v55
v_exp_f32 v56, v56
v_add_f32 v55, 1.0, v55
v_add_f32 v56, 1.0, v56
v_rcp_f32 v55, v55
v_rcp_f32 v56, v56
v_mul_f32 v178, v178, v55
v_mul_f32 v179, v179, v56
v_cvt_pk_bf16_f32 v25, v178, v179
v_cvt_pk_bf16_f32 v48, v180, v181
v_lshlrev_b32 v180, 16, v48
v_and_b32 v181, s61, v48
v_mul_f32 v49, s60, v180
v_mul_f32 v50, s60, v181
v_exp_f32 v49, v49
v_exp_f32 v50, v50
v_add_f32 v49, 1.0, v49
v_add_f32 v50, 1.0, v50
v_rcp_f32 v49, v49
v_rcp_f32 v50, v50
v_mul_f32 v180, v180, v49
v_mul_f32 v181, v181, v50
v_cvt_pk_bf16_f32 v26, v180, v181
v_cvt_pk_bf16_f32 v54, v182, v183
v_lshlrev_b32 v182, 16, v54
v_and_b32 v183, s61, v54
v_mul_f32 v55, s60, v182
v_mul_f32 v56, s60, v183
v_exp_f32 v55, v55
v_exp_f32 v56, v56
v_add_f32 v55, 1.0, v55
v_add_f32 v56, 1.0, v56
v_rcp_f32 v55, v55
v_rcp_f32 v56, v56
v_mul_f32 v182, v182, v55
v_mul_f32 v183, v183, v56
v_cvt_pk_bf16_f32 v27, v182, v183
v_cvt_pk_bf16_f32 v48, v184, v185
v_lshlrev_b32 v184, 16, v48
v_and_b32 v185, s61, v48
v_mul_f32 v49, s60, v184
v_mul_f32 v50, s60, v185
v_exp_f32 v49, v49
v_exp_f32 v50, v50
v_add_f32 v49, 1.0, v49
v_add_f32 v50, 1.0, v50
v_rcp_f32 v49, v49
v_rcp_f32 v50, v50
v_mul_f32 v184, v184, v49
v_mul_f32 v185, v185, v50
v_cvt_pk_bf16_f32 v28, v184, v185
v_cvt_pk_bf16_f32 v54, v186, v187
v_lshlrev_b32 v186, 16, v54
v_and_b32 v187, s61, v54
v_mul_f32 v55, s60, v186
v_mul_f32 v56, s60, v187
v_exp_f32 v55, v55
v_exp_f32 v56, v56
v_add_f32 v55, 1.0, v55
v_add_f32 v56, 1.0, v56
v_rcp_f32 v55, v55
v_rcp_f32 v56, v56
v_mul_f32 v186, v186, v55
v_mul_f32 v187, v187, v56
v_cvt_pk_bf16_f32 v29, v186, v187
v_cvt_pk_bf16_f32 v48, v188, v189
v_lshlrev_b32 v188, 16, v48
v_and_b32 v189, s61, v48
v_mul_f32 v49, s60, v188
v_mul_f32 v50, s60, v189
v_exp_f32 v49, v49
v_exp_f32 v50, v50
v_add_f32 v49, 1.0, v49
v_add_f32 v50, 1.0, v50
v_rcp_f32 v49, v49
v_rcp_f32 v50, v50
v_mul_f32 v188, v188, v49
v_mul_f32 v189, v189, v50
v_cvt_pk_bf16_f32 v30, v188, v189
v_cvt_pk_bf16_f32 v54, v190, v191
v_lshlrev_b32 v190, 16, v54
v_and_b32 v191, s61, v54
v_mul_f32 v55, s60, v190
v_mul_f32 v56, s60, v191
v_exp_f32 v55, v55
v_exp_f32 v56, v56
v_add_f32 v55, 1.0, v55
v_add_f32 v56, 1.0, v56
v_rcp_f32 v55, v55
v_rcp_f32 v56, v56
v_mul_f32 v190, v190, v55
v_mul_f32 v191, v191, v56
v_cvt_pk_bf16_f32 v31, v190, v191
s_mov_b32 s57, 0
buffer_load_dwordx4 v[192:195], v5, s[24:27], s57 offen offset:256
s_mov_b32 s57, 0
buffer_load_dwordx4 v[196:199], v5, s[24:27], s57 offen offset:512
s_mov_b32 s57, 0
buffer_load_dwordx4 v[200:203], v5, s[24:27], s57 offen offset:768
s_mov_b32 s57, 1024
buffer_load_dwordx4 v[204:207], v5, s[24:27], s57 offen offset:256
s_mov_b32 s57, 1024
buffer_load_dwordx4 v[208:211], v5, s[24:27], s57 offen offset:512
s_mov_b32 s57, 1024
buffer_load_dwordx4 v[212:215], v5, s[24:27], s57 offen offset:768
s_mov_b32 s57, 2048
buffer_load_dwordx4 v[216:219], v5, s[24:27], s57 offen offset:256
s_mov_b32 s57, 2048
buffer_load_dwordx4 v[220:223], v5, s[24:27], s57 offen offset:512
s_mov_b32 s57, 2048
buffer_load_dwordx4 v[224:227], v5, s[24:27], s57 offen offset:768
s_mov_b32 s57, 3072
buffer_load_dwordx4 v[228:231], v5, s[24:27], s57 offen offset:256
s_mov_b32 s57, 3072
buffer_load_dwordx4 v[232:235], v5, s[24:27], s57 offen offset:512
s_mov_b32 s57, 3072
buffer_load_dwordx4 v[236:239], v5, s[24:27], s57 offen offset:768
s_mov_b32 s57, 8000000
v_mul_lo_u32 v8, s57, v8
v_lshlrev_b32 v7, 2, v3
v_add_u32 v7, s6, v7
v_mul_u32_u24 v6, 640, v7
v_add_u32 v6, v6, v8
v_and_b32 v13, 7, v2
v_lshl_add_u32 v6, v13, 4, v6
s_mov_b32 s57, 12500
v_cmp_gt_u32 vcc, s57, v7
v_mov_b32 v13, 0x80000000
v_add_u32 v14, 0, v6
v_cndmask_b32 v172, v13, v14, vcc
s_mov_b32 s57, 12499
v_cmp_gt_u32 vcc, s57, v7
v_mov_b32 v13, 0x80000000
v_add_u32 v14, 640, v6
v_cndmask_b32 v173, v13, v14, vcc
s_mov_b32 s57, 12498
v_cmp_gt_u32 vcc, s57, v7
v_mov_b32 v13, 0x80000000
v_add_u32 v14, 1280, v6
v_cndmask_b32 v174, v13, v14, vcc
s_mov_b32 s57, 12497
v_cmp_gt_u32 vcc, s57, v7
v_mov_b32 v13, 0x80000000
v_add_u32 v14, 1920, v6
v_cndmask_b32 v175, v13, v14, vcc
s_barrier
ds_read_b128 v[48:51], v11 offset:0
ds_read_b128 v[52:55], v11 offset:1024
ds_read_b128 v[56:59], v11 offset:2048
ds_read_b128 v[60:63], v11 offset:3072
s_waitcnt lgkmcnt(3)
v_mfma_f32_16x16x32_bf16 v[64:67], v[16:19], v[48:51], 0
ds_read_b128 v[48:51], v11 offset:4096
s_waitcnt lgkmcnt(3)
v_mfma_f32_16x16x32_bf16 v[64:67], v[20:23], v[52:55], v[64:67]
ds_read_b128 v[52:55], v11 offset:5120
s_waitcnt lgkmcnt(3)
v_mfma_f32_16x16x32_bf16 v[64:67], v[24:27], v[56:59], v[64:67]
ds_read_b128 v[56:59], v11 offset:6144
s_waitcnt lgkmcnt(3)
v_mfma_f32_16x16x32_bf16 v[64:67], v[28:31], v[60:63], v[64:67]
ds_read_b128 v[60:63], v11 offset:7168
s_waitcnt lgkmcnt(3)
v_mfma_f32_16x16x32_bf16 v[68:71], v[16:19], v[48:51], 0
ds_read_b128 v[48:51], v11 offset:8192
s_waitcnt lgkmcnt(3)
v_mfma_f32_16x16x32_bf16 v[68:71], v[20:23], v[52:55], v[68:71]
ds_read_b128 v[52:55], v11 offset:9216
s_waitcnt lgkmcnt(3)
v_mfma_f32_16x16x32_bf16 v[68:71], v[24:27], v[56:59], v[68:71]
ds_read_b128 v[56:59], v11 offset:10240
s_waitcnt lgkmcnt(3)
v_mfma_f32_16x16x32_bf16 v[68:71], v[28:31], v[60:63], v[68:71]
ds_read_b128 v[60:63], v11 offset:11264
s_waitcnt lgkmcnt(3)
v_mfma_f32_16x16x32_bf16 v[72:75], v[16:19], v[48:51], 0
ds_read_b128 v[48:51], v11 offset:12288
s_waitcnt lgkmcnt(3)
v_mfma_f32_16x16x32_bf16 v[72:75], v[20:23], v[52:55], v[72:75]
ds_read_b128 v[52:55], v11 offset:13312
s_waitcnt lgkmcnt(3)
v_mfma_f32_16x16x32_bf16 v[72:75], v[24:27], v[56:59], v[72:75]
ds_read_b128 v[56:59], v11 offset:14336
s_waitcnt lgkmcnt(3)
v_mfma_f32_16x16x32_bf16 v[72:75], v[28:31], v[60:63], v[72:75]
ds_read_b128 v[60:63], v11 offset:15360
s_waitcnt lgkmcnt(3)
v_mfma_f32_16x16x32_bf16 v[76:79], v[16:19], v[48:51], 0
ds_read_b128 v[48:51], v11 offset:16384
s_waitcnt lgkmcnt(3)
v_mfma_f32_16x16x32_bf16 v[76:79], v[20:23], v[52:55], v[76:79]
ds_read_b128 v[52:55], v11 offset:17408
s_waitcnt lgkmcnt(3)
v_mfma_f32_16x16x32_bf16 v[76:79], v[24:27], v[56:59], v[76:79]
ds_read_b128 v[56:59], v11 offset:18432
s_waitcnt lgkmcnt(3)
v_mfma_f32_16x16x32_bf16 v[76:79], v[28:31], v[60:63], v[76:79]
ds_read_b128 v[60:63], v11 offset:19456
s_waitcnt lgkmcnt(3)
v_mfma_f32_16x16x32_bf16 v[80:83], v[16:19], v[48:51], 0
ds_read_b128 v[48:51], v11 offset:20480
s_waitcnt lgkmcnt(3)
v_mfma_f32_16x16x32_bf16 v[80:83], v[20:23], v[52:55], v[80:83]
ds_read_b128 v[52:55], v11 offset:21504
s_waitcnt lgkmcnt(3)
v_mfma_f32_16x16x32_bf16 v[80:83], v[24:27], v[56:59], v[80:83]
ds_read_b128 v[56:59], v11 offset:22528
s_waitcnt lgkmcnt(3)
v_mfma_f32_16x16x32_bf16 v[80:83], v[28:31], v[60:63], v[80:83]
ds_read_b128 v[60:63], v11 offset:23552
s_waitcnt lgkmcnt(3)
v_mfma_f32_16x16x32_bf16 v[84:87], v[16:19], v[48:51], 0
ds_read_b128 v[48:51], v11 offset:24576
s_waitcnt lgkmcnt(3)
v_mfma_f32_16x16x32_bf16 v[84:87], v[20:23], v[52:55], v[84:87]
ds_read_b128 v[52:55], v11 offset:25600
s_waitcnt lgkmcnt(3)
v_mfma_f32_16x16x32_bf16 v[84:87], v[24:27], v[56:59], v[84:87]
ds_read_b128 v[56:59], v11 offset:26624
s_waitcnt lgkmcnt(3)
v_mfma_f32_16x16x32_bf16 v[84:87], v[28:31], v[60:63], v[84:87]
ds_read_b128 v[60:63], v11 offset:27648
s_waitcnt lgkmcnt(3)
v_mfma_f32_16x16x32_bf16 v[88:91], v[16:19], v[48:51], 0
ds_read_b128 v[48:51], v11 offset:28672
s_waitcnt lgkmcnt(3)
v_mfma_f32_16x16x32_bf16 v[88:91], v[20:23], v[52:55], v[88:91]
ds_read_b128 v[52:55], v11 offset:29696
s_waitcnt lgkmcnt(3)
v_mfma_f32_16x16x32_bf16 v[88:91], v[24:27], v[56:59], v[88:91]
ds_read_b128 v[56:59], v11 offset:30720
s_waitcnt lgkmcnt(3)
v_mfma_f32_16x16x32_bf16 v[88:91], v[28:31], v[60:63], v[88:91]
ds_read_b128 v[60:63], v11 offset:31744
s_waitcnt lgkmcnt(3)
v_mfma_f32_16x16x32_bf16 v[92:95], v[16:19], v[48:51], 0
ds_read_b128 v[48:51], v9 offset:0
s_waitcnt lgkmcnt(3)
v_mfma_f32_16x16x32_bf16 v[92:95], v[20:23], v[52:55], v[92:95]
ds_read_b128 v[52:55], v9 offset:1024
s_waitcnt lgkmcnt(3)
v_mfma_f32_16x16x32_bf16 v[92:95], v[24:27], v[56:59], v[92:95]
ds_read_b128 v[56:59], v9 offset:2048
s_waitcnt lgkmcnt(3)
v_mfma_f32_16x16x32_bf16 v[92:95], v[28:31], v[60:63], v[92:95]
ds_read_b128 v[60:63], v9 offset:3072
s_waitcnt lgkmcnt(3)
v_mfma_f32_16x16x32_bf16 v[96:99], v[16:19], v[48:51], 0
ds_read_b128 v[48:51], v9 offset:4096
s_waitcnt lgkmcnt(3)
v_mfma_f32_16x16x32_bf16 v[96:99], v[20:23], v[52:55], v[96:99]
ds_read_b128 v[52:55], v9 offset:5120
s_waitcnt lgkmcnt(3)
v_mfma_f32_16x16x32_bf16 v[96:99], v[24:27], v[56:59], v[96:99]
ds_read_b128 v[56:59], v9 offset:6144
s_waitcnt lgkmcnt(3)
v_mfma_f32_16x16x32_bf16 v[96:99], v[28:31], v[60:63], v[96:99]
ds_read_b128 v[60:63], v9 offset:7168
s_waitcnt lgkmcnt(3)
v_mfma_f32_16x16x32_bf16 v[100:103], v[16:19], v[48:51], 0
ds_read_b128 v[48:51], v9 offset:8192
s_waitcnt lgkmcnt(3)
v_mfma_f32_16x16x32_bf16 v[100:103], v[20:23], v[52:55], v[100:103]
ds_read_b128 v[52:55], v9 offset:9216
s_waitcnt lgkmcnt(3)
v_mfma_f32_16x16x32_bf16 v[100:103], v[24:27], v[56:59], v[100:103]
ds_read_b128 v[56:59], v9 offset:10240
s_waitcnt lgkmcnt(3)
v_mfma_f32_16x16x32_bf16 v[100:103], v[28:31], v[60:63], v[100:103]
ds_read_b128 v[60:63], v9 offset:11264
s_waitcnt lgkmcnt(3)
v_mfma_f32_16x16x32_bf16 v[104:107], v[16:19], v[48:51], 0
ds_read_b128 v[48:51], v9 offset:12288
s_waitcnt lgkmcnt(3)
v_mfma_f32_16x16x32_bf16 v[104:107], v[20:23], v[52:55], v[104:107]
ds_read_b128 v[52:55], v9 offset:13312
s_waitcnt lgkmcnt(3)
v_mfma_f32_16x16x32_bf16 v[104:107], v[24:27], v[56:59], v[104:107]
ds_read_b128 v[56:59], v9 offset:14336
s_waitcnt lgkmcnt(3)
v_mfma_f32_16x16x32_bf16 v[104:107], v[28:31], v[60:63], v[104:107]
ds_read_b128 v[60:63], v9 offset:15360
s_waitcnt lgkmcnt(3)
v_mfma_f32_16x16x32_bf16 v[108:111], v[16:19], v[48:51], 0
ds_read_b128 v[48:51], v9 offset:16384
s_waitcnt lgkmcnt(3)
v_mfma_f32_16x16x32_bf16 v[108:111], v[20:23], v[52:55], v[108:111]
ds_read_b128 v[52:55], v9 offset:17408
s_waitcnt lgkmcnt(3)
v_mfma_f32_16x16x32_bf16 v[108:111], v[24:27], v[56:59], v[108:111]
ds_read_b128 v[56:59], v9 offset:18432
s_waitcnt lgkmcnt(3)
v_mfma_f32_16x16x32_bf16 v[108:111], v[28:31], v[60:63], v[108:111]
ds_read_b128 v[60:63], v9 offset:19456
s_waitcnt lgkmcnt(3)
v_mfma_f32_16x16x32_bf16 v[112:115], v[16:19], v[48:51], 0
ds_read_b128 v[48:51], v9 offset:20480
s_waitcnt lgkmcnt(3)
v_mfma_f32_16x16x32_bf16 v[112:115], v[20:23], v[52:55], v[112:115]
ds_read_b128 v[52:55], v9 offset:21504
s_waitcnt lgkmcnt(3)
v_mfma_f32_16x16x32_bf16 v[112:115], v[24:27], v[56:59], v[112:115]
ds_read_b128 v[56:59], v9 offset:22528
s_waitcnt lgkmcnt(3)
v_mfma_f32_16x16x32_bf16 v[112:115], v[28:31], v[60:63], v[112:115]
ds_read_b128 v[60:63], v9 offset:23552
s_waitcnt lgkmcnt(3)
v_mfma_f32_16x16x32_bf16 v[116:119], v[16:19], v[48:51], 0
ds_read_b128 v[48:51], v9 offset:24576
s_waitcnt lgkmcnt(3)
v_mfma_f32_16x16x32_bf16 v[116:119], v[20:23], v[52:55], v[116:119]
ds_read_b128 v[52:55], v9 offset:25600
s_waitcnt lgkmcnt(3)
v_mfma_f32_16x16x32_bf16 v[116:119], v[24:27], v[56:59], v[116:119]
ds_read_b128 v[56:59], v9 offset:26624
s_waitcnt lgkmcnt(3)
v_mfma_f32_16x16x32_bf16 v[116:119], v[28:31], v[60:63], v[116:119]
ds_read_b128 v[60:63], v9 offset:27648
s_waitcnt lgkmcnt(3)
v_mfma_f32_16x16x32_bf16 v[120:123], v[16:19], v[48:51], 0
ds_read_b128 v[48:51], v9 offset:28672
s_waitcnt lgkmcnt(3)
v_mfma_f32_16x16x32_bf16 v[120:123], v[20:23], v[52:55], v[120:123]
ds_read_b128 v[52:55], v9 offset:29696
s_waitcnt lgkmcnt(3)
v_mfma_f32_16x16x32_bf16 v[120:123], v[24:27], v[56:59], v[120:123]
ds_read_b128 v[56:59], v9 offset:30720
s_waitcnt lgkmcnt(3)
v_mfma_f32_16x16x32_bf16 v[120:123], v[28:31], v[60:63], v[120:123]
ds_read_b128 v[60:63], v9 offset:31744
s_waitcnt lgkmcnt(3)
v_mfma_f32_16x16x32_bf16 v[124:127], v[16:19], v[48:51], 0
ds_read_b128 v[48:51], v12 offset:0
s_waitcnt lgkmcnt(3)
v_mfma_f32_16x16x32_bf16 v[124:127], v[20:23], v[52:55], v[124:127]
ds_read_b128 v[52:55], v12 offset:1024
s_waitcnt lgkmcnt(3)
v_mfma_f32_16x16x32_bf16 v[124:127], v[24:27], v[56:59], v[124:127]
ds_read_b128 v[56:59], v12 offset:2048
s_waitcnt lgkmcnt(3)
v_mfma_f32_16x16x32_bf16 v[124:127], v[28:31], v[60:63], v[124:127]
ds_read_b128 v[60:63], v12 offset:3072
s_waitcnt lgkmcnt(3)
v_mfma_f32_16x16x32_bf16 v[128:131], v[16:19], v[48:51], 0
ds_read_b128 v[48:51], v12 offset:4096
s_waitcnt lgkmcnt(3)
v_mfma_f32_16x16x32_bf16 v[128:131], v[20:23], v[52:55], v[128:131]
ds_read_b128 v[52:55], v12 offset:5120
s_waitcnt lgkmcnt(3)
v_mfma_f32_16x16x32_bf16 v[128:131], v[24:27], v[56:59], v[128:131]
ds_read_b128 v[56:59], v12 offset:6144
s_waitcnt lgkmcnt(3)
v_mfma_f32_16x16x32_bf16 v[128:131], v[28:31], v[60:63], v[128:131]
ds_read_b128 v[60:63], v12 offset:7168
s_waitcnt lgkmcnt(3)
v_mfma_f32_16x16x32_bf16 v[132:135], v[16:19], v[48:51], 0
ds_read_b128 v[48:51], v12 offset:8192
s_waitcnt lgkmcnt(3)
v_mfma_f32_16x16x32_bf16 v[132:135], v[20:23], v[52:55], v[132:135]
ds_read_b128 v[52:55], v12 offset:9216
s_waitcnt lgkmcnt(3)
v_mfma_f32_16x16x32_bf16 v[132:135], v[24:27], v[56:59], v[132:135]
ds_read_b128 v[56:59], v12 offset:10240
s_waitcnt lgkmcnt(3)
v_mfma_f32_16x16x32_bf16 v[132:135], v[28:31], v[60:63], v[132:135]
ds_read_b128 v[60:63], v12 offset:11264
s_waitcnt lgkmcnt(3)
v_mfma_f32_16x16x32_bf16 v[136:139], v[16:19], v[48:51], 0
ds_read_b128 v[48:51], v12 offset:12288
s_waitcnt lgkmcnt(3)
v_mfma_f32_16x16x32_bf16 v[136:139], v[20:23], v[52:55], v[136:139]
ds_read_b128 v[52:55], v12 offset:13312
s_waitcnt lgkmcnt(3)
v_mfma_f32_16x16x32_bf16 v[136:139], v[24:27], v[56:59], v[136:139]
ds_read_b128 v[56:59], v12 offset:14336
s_waitcnt lgkmcnt(3)
v_mfma_f32_16x16x32_bf16 v[136:139], v[28:31], v[60:63], v[136:139]
ds_read_b128 v[60:63], v12 offset:15360
s_waitcnt lgkmcnt(3)
v_mfma_f32_16x16x32_bf16 v[140:143], v[16:19], v[48:51], 0
ds_read_b128 v[48:51], v12 offset:16384
s_waitcnt lgkmcnt(3)
v_mfma_f32_16x16x32_bf16 v[140:143], v[20:23], v[52:55], v[140:143]
ds_read_b128 v[52:55], v12 offset:17408
s_waitcnt lgkmcnt(3)
v_mfma_f32_16x16x32_bf16 v[140:143], v[24:27], v[56:59], v[140:143]
ds_read_b128 v[56:59], v12 offset:18432
s_waitcnt lgkmcnt(3)
v_mfma_f32_16x16x32_bf16 v[140:143], v[28:31], v[60:63], v[140:143]
ds_read_b128 v[60:63], v12 offset:19456
s_waitcnt lgkmcnt(3)
v_mfma_f32_16x16x32_bf16 v[144:147], v[16:19], v[48:51], 0
ds_read_b128 v[48:51], v12 offset:20480
s_waitcnt lgkmcnt(3)
v_mfma_f32_16x16x32_bf16 v[144:147], v[20:23], v[52:55], v[144:147]
ds_read_b128 v[52:55], v12 offset:21504
s_waitcnt lgkmcnt(3)
v_mfma_f32_16x16x32_bf16 v[144:147], v[24:27], v[56:59], v[144:147]
ds_read_b128 v[56:59], v12 offset:22528
s_waitcnt lgkmcnt(3)
v_mfma_f32_16x16x32_bf16 v[144:147], v[28:31], v[60:63], v[144:147]
ds_read_b128 v[60:63], v12 offset:23552
s_waitcnt lgkmcnt(3)
v_mfma_f32_16x16x32_bf16 v[148:151], v[16:19], v[48:51], 0
ds_read_b128 v[48:51], v12 offset:24576
s_waitcnt lgkmcnt(3)
v_mfma_f32_16x16x32_bf16 v[148:151], v[20:23], v[52:55], v[148:151]
ds_read_b128 v[52:55], v12 offset:25600
s_waitcnt lgkmcnt(3)
v_mfma_f32_16x16x32_bf16 v[148:151], v[24:27], v[56:59], v[148:151]
ds_read_b128 v[56:59], v12 offset:26624
s_waitcnt lgkmcnt(3)
v_mfma_f32_16x16x32_bf16 v[148:151], v[28:31], v[60:63], v[148:151]
ds_read_b128 v[60:63], v12 offset:27648
s_waitcnt lgkmcnt(3)
v_mfma_f32_16x16x32_bf16 v[152:155], v[16:19], v[48:51], 0
ds_read_b128 v[48:51], v12 offset:28672
s_waitcnt lgkmcnt(3)
v_mfma_f32_16x16x32_bf16 v[152:155], v[20:23], v[52:55], v[152:155]
ds_read_b128 v[52:55], v12 offset:29696
s_waitcnt lgkmcnt(3)
v_mfma_f32_16x16x32_bf16 v[152:155], v[24:27], v[56:59], v[152:155]
ds_read_b128 v[56:59], v12 offset:30720
s_waitcnt lgkmcnt(3)
v_mfma_f32_16x16x32_bf16 v[152:155], v[28:31], v[60:63], v[152:155]
ds_read_b128 v[60:63], v12 offset:31744
s_waitcnt lgkmcnt(3)
v_mfma_f32_16x16x32_bf16 v[156:159], v[16:19], v[48:51], 0
s_waitcnt lgkmcnt(2)
v_mfma_f32_16x16x32_bf16 v[156:159], v[20:23], v[52:55], v[156:159]
s_waitcnt lgkmcnt(1)
v_mfma_f32_16x16x32_bf16 v[156:159], v[24:27], v[56:59], v[156:159]
s_waitcnt lgkmcnt(0)
v_mfma_f32_16x16x32_bf16 v[156:159], v[28:31], v[60:63], v[156:159]
s_waitcnt vmcnt(0)
v_cvt_pk_bf16_f32 v160, v96, v100
v_cvt_pk_bf16_f32 v161, v128, v132
v_cvt_pk_bf16_f32 v48, v64, v68
v_and_b32 v49, s61, v48
v_lshlrev_b32 v48, 16, v48
v_lshlrev_b32 v50, 16, v192
v_and_b32 v51, s61, v192
v_pk_mul_f32 v[50:51], v[50:51], v[48:49]
v_cvt_pk_bf16_f32 v162, v50, v51
v_lshlrev_b32 v52, 16, v196
v_and_b32 v53, s61, v196
v_pk_mul_f32 v[52:53], v[52:53], v[48:49]
v_cvt_pk_bf16_f32 v163, v52, v53
v_lshlrev_b32 v54, 16, v200
v_and_b32 v55, s61, v200
v_pk_mul_f32 v[54:55], v[54:55], v[48:49]
v_cvt_pk_bf16_f32 v180, v54, v55
buffer_store_dwordx4 v[160:163], v172, s[48:51], 0 offen offset:0 sc1
v_cvt_pk_bf16_f32 v164, v104, v108
v_cvt_pk_bf16_f32 v165, v136, v140
v_cvt_pk_bf16_f32 v56, v72, v76
v_and_b32 v57, s61, v56
v_lshlrev_b32 v56, 16, v56
v_lshlrev_b32 v58, 16, v193
v_and_b32 v59, s61, v193
v_pk_mul_f32 v[58:59], v[58:59], v[56:57]
v_cvt_pk_bf16_f32 v166, v58, v59
v_lshlrev_b32 v60, 16, v197
v_and_b32 v61, s61, v197
v_pk_mul_f32 v[60:61], v[60:61], v[56:57]
v_cvt_pk_bf16_f32 v167, v60, v61
v_lshlrev_b32 v62, 16, v201
v_and_b32 v63, s61, v201
v_pk_mul_f32 v[62:63], v[62:63], v[56:57]
v_cvt_pk_bf16_f32 v181, v62, v63
buffer_store_dwordx4 v[164:167], v172, s[48:51], 0 offen offset:128 sc1
v_cvt_pk_bf16_f32 v160, v112, v116
v_cvt_pk_bf16_f32 v161, v144, v148
v_cvt_pk_bf16_f32 v48, v80, v84
v_and_b32 v49, s61, v48
v_lshlrev_b32 v48, 16, v48
v_lshlrev_b32 v50, 16, v194
v_and_b32 v51, s61, v194
v_pk_mul_f32 v[50:51], v[50:51], v[48:49]
v_cvt_pk_bf16_f32 v162, v50, v51
v_lshlrev_b32 v52, 16, v198
v_and_b32 v53, s61, v198
v_pk_mul_f32 v[52:53], v[52:53], v[48:49]
v_cvt_pk_bf16_f32 v163, v52, v53
v_lshlrev_b32 v54, 16, v202
v_and_b32 v55, s61, v202
v_pk_mul_f32 v[54:55], v[54:55], v[48:49]
v_cvt_pk_bf16_f32 v182, v54, v55
buffer_store_dwordx4 v[160:163], v172, s[48:51], 0 offen offset:256 sc1
v_cvt_pk_bf16_f32 v164, v120, v124
v_cvt_pk_bf16_f32 v165, v152, v156
v_cvt_pk_bf16_f32 v56, v88, v92
v_and_b32 v57, s61, v56
v_lshlrev_b32 v56, 16, v56
v_lshlrev_b32 v58, 16, v195
v_and_b32 v59, s61, v195
v_pk_mul_f32 v[58:59], v[58:59], v[56:57]
v_cvt_pk_bf16_f32 v166, v58, v59
v_lshlrev_b32 v60, 16, v199
v_and_b32 v61, s61, v199
v_pk_mul_f32 v[60:61], v[60:61], v[56:57]
v_cvt_pk_bf16_f32 v167, v60, v61
v_lshlrev_b32 v62, 16, v203
v_and_b32 v63, s61, v203
v_pk_mul_f32 v[62:63], v[62:63], v[56:57]
v_cvt_pk_bf16_f32 v183, v62, v63
buffer_store_dwordx4 v[164:167], v172, s[48:51], 0 offen offset:384 sc1
buffer_store_dwordx4 v[180:183], v172, s[48:51], 0 offen offset:512 sc1
v_cvt_pk_bf16_f32 v160, v97, v101
v_cvt_pk_bf16_f32 v161, v129, v133
v_cvt_pk_bf16_f32 v48, v65, v69
v_and_b32 v49, s61, v48
v_lshlrev_b32 v48, 16, v48
v_lshlrev_b32 v50, 16, v204
v_and_b32 v51, s61, v204
v_pk_mul_f32 v[50:51], v[50:51], v[48:49]
v_cvt_pk_bf16_f32 v162, v50, v51
v_lshlrev_b32 v52, 16, v208
v_and_b32 v53, s61, v208
v_pk_mul_f32 v[52:53], v[52:53], v[48:49]
v_cvt_pk_bf16_f32 v163, v52, v53
v_lshlrev_b32 v54, 16, v212
v_and_b32 v55, s61, v212
v_pk_mul_f32 v[54:55], v[54:55], v[48:49]
v_cvt_pk_bf16_f32 v184, v54, v55
buffer_store_dwordx4 v[160:163], v173, s[48:51], 0 offen offset:0 sc1
v_cvt_pk_bf16_f32 v164, v105, v109
v_cvt_pk_bf16_f32 v165, v137, v141
v_cvt_pk_bf16_f32 v56, v73, v77
v_and_b32 v57, s61, v56
v_lshlrev_b32 v56, 16, v56
v_lshlrev_b32 v58, 16, v205
v_and_b32 v59, s61, v205
v_pk_mul_f32 v[58:59], v[58:59], v[56:57]
v_cvt_pk_bf16_f32 v166, v58, v59
v_lshlrev_b32 v60, 16, v209
v_and_b32 v61, s61, v209
v_pk_mul_f32 v[60:61], v[60:61], v[56:57]
v_cvt_pk_bf16_f32 v167, v60, v61
v_lshlrev_b32 v62, 16, v213
v_and_b32 v63, s61, v213
v_pk_mul_f32 v[62:63], v[62:63], v[56:57]
v_cvt_pk_bf16_f32 v185, v62, v63
buffer_store_dwordx4 v[164:167], v173, s[48:51], 0 offen offset:128 sc1
v_cvt_pk_bf16_f32 v160, v113, v117
v_cvt_pk_bf16_f32 v161, v145, v149
v_cvt_pk_bf16_f32 v48, v81, v85
v_and_b32 v49, s61, v48
v_lshlrev_b32 v48, 16, v48
v_lshlrev_b32 v50, 16, v206
v_and_b32 v51, s61, v206
v_pk_mul_f32 v[50:51], v[50:51], v[48:49]
v_cvt_pk_bf16_f32 v162, v50, v51
v_lshlrev_b32 v52, 16, v210
v_and_b32 v53, s61, v210
v_pk_mul_f32 v[52:53], v[52:53], v[48:49]
v_cvt_pk_bf16_f32 v163, v52, v53
v_lshlrev_b32 v54, 16, v214
v_and_b32 v55, s61, v214
v_pk_mul_f32 v[54:55], v[54:55], v[48:49]
v_cvt_pk_bf16_f32 v186, v54, v55
buffer_store_dwordx4 v[160:163], v173, s[48:51], 0 offen offset:256 sc1
v_cvt_pk_bf16_f32 v164, v121, v125
v_cvt_pk_bf16_f32 v165, v153, v157
v_cvt_pk_bf16_f32 v56, v89, v93
v_and_b32 v57, s61, v56
v_lshlrev_b32 v56, 16, v56
v_lshlrev_b32 v58, 16, v207
v_and_b32 v59, s61, v207
v_pk_mul_f32 v[58:59], v[58:59], v[56:57]
v_cvt_pk_bf16_f32 v166, v58, v59
v_lshlrev_b32 v60, 16, v211
v_and_b32 v61, s61, v211
v_pk_mul_f32 v[60:61], v[60:61], v[56:57]
v_cvt_pk_bf16_f32 v167, v60, v61
v_lshlrev_b32 v62, 16, v215
v_and_b32 v63, s61, v215
v_pk_mul_f32 v[62:63], v[62:63], v[56:57]
v_cvt_pk_bf16_f32 v187, v62, v63
buffer_store_dwordx4 v[164:167], v173, s[48:51], 0 offen offset:384 sc1
buffer_store_dwordx4 v[184:187], v173, s[48:51], 0 offen offset:512 sc1
v_cvt_pk_bf16_f32 v160, v98, v102
v_cvt_pk_bf16_f32 v161, v130, v134
v_cvt_pk_bf16_f32 v48, v66, v70
v_and_b32 v49, s61, v48
v_lshlrev_b32 v48, 16, v48
v_lshlrev_b32 v50, 16, v216
v_and_b32 v51, s61, v216
v_pk_mul_f32 v[50:51], v[50:51], v[48:49]
v_cvt_pk_bf16_f32 v162, v50, v51
v_lshlrev_b32 v52, 16, v220
v_and_b32 v53, s61, v220
v_pk_mul_f32 v[52:53], v[52:53], v[48:49]
v_cvt_pk_bf16_f32 v163, v52, v53
v_lshlrev_b32 v54, 16, v224
v_and_b32 v55, s61, v224
v_pk_mul_f32 v[54:55], v[54:55], v[48:49]
v_cvt_pk_bf16_f32 v180, v54, v55
buffer_store_dwordx4 v[160:163], v174, s[48:51], 0 offen offset:0 sc1
v_cvt_pk_bf16_f32 v164, v106, v110
v_cvt_pk_bf16_f32 v165, v138, v142
v_cvt_pk_bf16_f32 v56, v74, v78
v_and_b32 v57, s61, v56
v_lshlrev_b32 v56, 16, v56
v_lshlrev_b32 v58, 16, v217
v_and_b32 v59, s61, v217
v_pk_mul_f32 v[58:59], v[58:59], v[56:57]
v_cvt_pk_bf16_f32 v166, v58, v59
v_lshlrev_b32 v60, 16, v221
v_and_b32 v61, s61, v221
v_pk_mul_f32 v[60:61], v[60:61], v[56:57]
v_cvt_pk_bf16_f32 v167, v60, v61
v_lshlrev_b32 v62, 16, v225
v_and_b32 v63, s61, v225
v_pk_mul_f32 v[62:63], v[62:63], v[56:57]
v_cvt_pk_bf16_f32 v181, v62, v63
buffer_store_dwordx4 v[164:167], v174, s[48:51], 0 offen offset:128 sc1
v_cvt_pk_bf16_f32 v160, v114, v118
v_cvt_pk_bf16_f32 v161, v146, v150
v_cvt_pk_bf16_f32 v48, v82, v86
v_and_b32 v49, s61, v48
v_lshlrev_b32 v48, 16, v48
v_lshlrev_b32 v50, 16, v218
v_and_b32 v51, s61, v218
v_pk_mul_f32 v[50:51], v[50:51], v[48:49]
v_cvt_pk_bf16_f32 v162, v50, v51
v_lshlrev_b32 v52, 16, v222
v_and_b32 v53, s61, v222
v_pk_mul_f32 v[52:53], v[52:53], v[48:49]
v_cvt_pk_bf16_f32 v163, v52, v53
v_lshlrev_b32 v54, 16, v226
v_and_b32 v55, s61, v226
v_pk_mul_f32 v[54:55], v[54:55], v[48:49]
v_cvt_pk_bf16_f32 v182, v54, v55
buffer_store_dwordx4 v[160:163], v174, s[48:51], 0 offen offset:256 sc1
v_cvt_pk_bf16_f32 v164, v122, v126
v_cvt_pk_bf16_f32 v165, v154, v158
v_cvt_pk_bf16_f32 v56, v90, v94
v_and_b32 v57, s61, v56
v_lshlrev_b32 v56, 16, v56
v_lshlrev_b32 v58, 16, v219
v_and_b32 v59, s61, v219
v_pk_mul_f32 v[58:59], v[58:59], v[56:57]
v_cvt_pk_bf16_f32 v166, v58, v59
v_lshlrev_b32 v60, 16, v223
v_and_b32 v61, s61, v223
v_pk_mul_f32 v[60:61], v[60:61], v[56:57]
v_cvt_pk_bf16_f32 v167, v60, v61
v_lshlrev_b32 v62, 16, v227
v_and_b32 v63, s61, v227
v_pk_mul_f32 v[62:63], v[62:63], v[56:57]
v_cvt_pk_bf16_f32 v183, v62, v63
buffer_store_dwordx4 v[164:167], v174, s[48:51], 0 offen offset:384 sc1
buffer_store_dwordx4 v[180:183], v174, s[48:51], 0 offen offset:512 sc1
v_cvt_pk_bf16_f32 v160, v99, v103
v_cvt_pk_bf16_f32 v161, v131, v135
v_cvt_pk_bf16_f32 v48, v67, v71
v_and_b32 v49, s61, v48
v_lshlrev_b32 v48, 16, v48
v_lshlrev_b32 v50, 16, v228
v_and_b32 v51, s61, v228
v_pk_mul_f32 v[50:51], v[50:51], v[48:49]
v_cvt_pk_bf16_f32 v162, v50, v51
v_lshlrev_b32 v52, 16, v232
v_and_b32 v53, s61, v232
v_pk_mul_f32 v[52:53], v[52:53], v[48:49]
v_cvt_pk_bf16_f32 v163, v52, v53
v_lshlrev_b32 v54, 16, v236
v_and_b32 v55, s61, v236
v_pk_mul_f32 v[54:55], v[54:55], v[48:49]
v_cvt_pk_bf16_f32 v184, v54, v55
buffer_store_dwordx4 v[160:163], v175, s[48:51], 0 offen offset:0 sc1
v_cvt_pk_bf16_f32 v164, v107, v111
v_cvt_pk_bf16_f32 v165, v139, v143
v_cvt_pk_bf16_f32 v56, v75, v79
v_and_b32 v57, s61, v56
v_lshlrev_b32 v56, 16, v56
v_lshlrev_b32 v58, 16, v229
v_and_b32 v59, s61, v229
v_pk_mul_f32 v[58:59], v[58:59], v[56:57]
v_cvt_pk_bf16_f32 v166, v58, v59
v_lshlrev_b32 v60, 16, v233
v_and_b32 v61, s61, v233
v_pk_mul_f32 v[60:61], v[60:61], v[56:57]
v_cvt_pk_bf16_f32 v167, v60, v61
v_lshlrev_b32 v62, 16, v237
v_and_b32 v63, s61, v237
v_pk_mul_f32 v[62:63], v[62:63], v[56:57]
v_cvt_pk_bf16_f32 v185, v62, v63
buffer_store_dwordx4 v[164:167], v175, s[48:51], 0 offen offset:128 sc1
v_cvt_pk_bf16_f32 v160, v115, v119
v_cvt_pk_bf16_f32 v161, v147, v151
v_cvt_pk_bf16_f32 v48, v83, v87
v_and_b32 v49, s61, v48
v_lshlrev_b32 v48, 16, v48
v_lshlrev_b32 v50, 16, v230
v_and_b32 v51, s61, v230
v_pk_mul_f32 v[50:51], v[50:51], v[48:49]
v_cvt_pk_bf16_f32 v162, v50, v51
v_lshlrev_b32 v52, 16, v234
v_and_b32 v53, s61, v234
v_pk_mul_f32 v[52:53], v[52:53], v[48:49]
v_cvt_pk_bf16_f32 v163, v52, v53
v_lshlrev_b32 v54, 16, v238
v_and_b32 v55, s61, v238
v_pk_mul_f32 v[54:55], v[54:55], v[48:49]
v_cvt_pk_bf16_f32 v186, v54, v55
buffer_store_dwordx4 v[160:163], v175, s[48:51], 0 offen offset:256 sc1
v_cvt_pk_bf16_f32 v164, v123, v127
v_cvt_pk_bf16_f32 v165, v155, v159
v_cvt_pk_bf16_f32 v56, v91, v95
v_and_b32 v57, s61, v56
v_lshlrev_b32 v56, 16, v56
v_lshlrev_b32 v58, 16, v231
v_and_b32 v59, s61, v231
v_pk_mul_f32 v[58:59], v[58:59], v[56:57]
v_cvt_pk_bf16_f32 v166, v58, v59
v_lshlrev_b32 v60, 16, v235
v_and_b32 v61, s61, v235
v_pk_mul_f32 v[60:61], v[60:61], v[56:57]
v_cvt_pk_bf16_f32 v167, v60, v61
v_lshlrev_b32 v62, 16, v239
v_and_b32 v63, s61, v239
v_pk_mul_f32 v[62:63], v[62:63], v[56:57]
v_cvt_pk_bf16_f32 v187, v62, v63
buffer_store_dwordx4 v[164:167], v175, s[48:51], 0 offen offset:384 sc1
buffer_store_dwordx4 v[184:187], v175, s[48:51], 0 offen offset:512 sc1
s_endpgm
K1_HELP:
s_waitcnt lgkmcnt(0)
s_mov_b32 s40, s16
s_mov_b32 s41, s17
s_mov_b32 s42, 32768
s_mov_b32 s43, 0x20000
s_mov_b32 s44, s18
s_mov_b32 s45, s19
s_mov_b32 s46, 98304
s_mov_b32 s47, 0x20000
v_subrev_u32 v2, 256, v0
v_and_b32 v3, 15, v2
v_lshrrev_b32 v4, 4, v2
v_lshlrev_b32 v5, 11, v4
v_lshl_add_u32 v5, v3, 4, v5
v_and_b32 v6, 3, v4
v_lshrrev_b32 v7, 2, v4
v_lshlrev_b32 v8, 5, v6
v_lshl_add_u32 v8, v7, 1, v8
v_mul_u32_u24 v8, 768, v8
v_lshl_add_u32 v8, v3, 4, v8
v_lshlrev_b32 v9, 10, v7
v_lshl_add_u32 v9, v6, 8, v9
v_lshl_add_u32 v9, v3, 4, v9
v_add_u32 v10, 98304, v9
v_add_u32 v11, 32768, v9
v_add_u32 v12, 65536, v9
s_mov_b32 s60, 0x05040100
s_mov_b32 s61, 0x07060302
buffer_load_dwordx4 v[64:67], v5, s[40:43], 0 offen offset:0
buffer_load_dwordx4 v[68:71], v5, s[40:43], 0 offen offset:256
buffer_load_dwordx4 v[72:75], v5, s[40:43], 0 offen offset:512
buffer_load_dwordx4 v[76:79], v5, s[40:43], 0 offen offset:768
buffer_load_dwordx4 v[80:83], v5, s[40:43], 0 offen offset:1024
buffer_load_dwordx4 v[84:87], v5, s[40:43], 0 offen offset:1280
buffer_load_dwordx4 v[88:91], v5, s[40:43], 0 offen offset:1536
buffer_load_dwordx4 v[92:95], v5, s[40:43], 0 offen offset:1792
s_mov_b32 s57, 0
buffer_load_dwordx4 v[96:99], v8, s[44:47], s57 offen offset:256
s_mov_b32 s57, 6144
buffer_load_dwordx4 v[100:103], v8, s[44:47], s57 offen offset:256
s_mov_b32 s57, 12288
buffer_load_dwordx4 v[104:107], v8, s[44:47], s57 offen offset:256
s_mov_b32 s57, 18432
buffer_load_dwordx4 v[108:111], v8, s[44:47], s57 offen offset:256
s_mov_b32 s57, 768
buffer_load_dwordx4 v[112:115], v8, s[44:47], s57 offen offset:256
s_mov_b32 s57, 6912
buffer_load_dwordx4 v[116:119], v8, s[44:47], s57 offen offset:256
s_mov_b32 s57, 13056
buffer_load_dwordx4 v[120:123], v8, s[44:47], s57 offen offset:256
s_mov_b32 s57, 19200
buffer_load_dwordx4 v[124:127], v8, s[44:47], s57 offen offset:256
s_waitcnt vmcnt(8)
v_perm_b32 v32, v68, v64, s60
v_perm_b32 v33, v76, v72, s60
v_perm_b32 v34, v84, v80, s60
v_perm_b32 v35, v92, v88, s60
ds_write_b128 v10, v[32:35] offset:0
v_perm_b32 v36, v68, v64, s61
v_perm_b32 v37, v76, v72, s61
v_perm_b32 v38, v84, v80, s61
v_perm_b32 v39, v92, v88, s61
ds_write_b128 v10, v[36:39] offset:4096
v_perm_b32 v40, v69, v65, s60
v_perm_b32 v41, v77, v73, s60
v_perm_b32 v42, v85, v81, s60
v_perm_b32 v43, v93, v89, s60
ds_write_b128 v10, v[40:43] offset:8192
v_perm_b32 v44, v69, v65, s61
v_perm_b32 v45, v77, v73, s61
v_perm_b32 v46, v85, v81, s61
v_perm_b32 v47, v93, v89, s61
ds_write_b128 v10, v[44:47] offset:12288
v_perm_b32 v32, v70, v66, s60
v_perm_b32 v33, v78, v74, s60
v_perm_b32 v34, v86, v82, s60
v_perm_b32 v35, v94, v90, s60
ds_write_b128 v10, v[32:35] offset:16384
v_perm_b32 v36, v70, v66, s61
v_perm_b32 v37, v78, v74, s61
v_perm_b32 v38, v86, v82, s61
v_perm_b32 v39, v94, v90, s61
ds_write_b128 v10, v[36:39] offset:20480
v_perm_b32 v40, v71, v67, s60
v_perm_b32 v41, v79, v75, s60
v_perm_b32 v42, v87, v83, s60
v_perm_b32 v43, v95, v91, s60
ds_write_b128 v10, v[40:43] offset:24576
v_perm_b32 v44, v71, v67, s61
v_perm_b32 v45, v79, v75, s61
v_perm_b32 v46, v87, v83, s61
v_perm_b32 v47, v95, v91, s61
ds_write_b128 v10, v[44:47] offset:28672
s_waitcnt lgkmcnt(0)
s_barrier
s_mov_b32 s57, 0
buffer_load_dwordx4 v[128:131], v8, s[44:47], s57 offen offset:0
s_mov_b32 s57, 6144
buffer_load_dwordx4 v[132:135], v8, s[44:47], s57 offen offset:0
s_mov_b32 s57, 12288
buffer_load_dwordx4 v[136:139], v8, s[44:47], s57 offen offset:0
s_mov_b32 s57, 18432
buffer_load_dwordx4 v[140:143], v8, s[44:47], s57 offen offset:0
s_mov_b32 s57, 768
buffer_load_dwordx4 v[144:147], v8, s[44:47], s57 offen offset:0
s_mov_b32 s57, 6912
buffer_load_dwordx4 v[148:151], v8, s[44:47], s57 offen offset:0
s_mov_b32 s57, 13056
buffer_load_dwordx4 v[152:155], v8, s[44:47], s57 offen offset:0
s_mov_b32 s57, 19200
buffer_load_dwordx4 v[156:159], v8, s[44:47], s57 offen offset:0
s_mov_b32 s57, 0
buffer_load_dwordx4 v[160:163], v8, s[44:47], s57 offen offset:512
s_mov_b32 s57, 6144
buffer_load_dwordx4 v[164:167], v8, s[44:47], s57 offen offset:512
s_mov_b32 s57, 12288
buffer_load_dwordx4 v[168:171], v8, s[44:47], s57 offen offset:512
s_mov_b32 s57, 18432
buffer_load_dwordx4 v[172:175], v8, s[44:47], s57 offen offset:512
s_mov_b32 s57, 768
buffer_load_dwordx4 v[176:179], v8, s[44:47], s57 offen offset:512
s_mov_b32 s57, 6912
buffer_load_dwordx4 v[180:183], v8, s[44:47], s57 offen offset:512
s_mov_b32 s57, 13056
buffer_load_dwordx4 v[184:187], v8, s[44:47], s57 offen offset:512
s_mov_b32 s57, 19200
buffer_load_dwordx4 v[188:191], v8, s[44:47], s57 offen offset:512
s_waitcnt vmcnt(16)
v_perm_b32 v32, v100, v96, s60
v_perm_b32 v33, v108, v104, s60
v_perm_b32 v34, v116, v112, s60
v_perm_b32 v35, v124, v120, s60
ds_write_b128 v11, v[32:35] offset:0
v_perm_b32 v36, v100, v96, s61
v_perm_b32 v37, v108, v104, s61
v_perm_b32 v38, v116, v112, s61
v_perm_b32 v39, v124, v120, s61
ds_write_b128 v11, v[36:39] offset:4096
v_perm_b32 v40, v101, v97, s60
v_perm_b32 v41, v109, v105, s60
v_perm_b32 v42, v117, v113, s60
v_perm_b32 v43, v125, v121, s60
ds_write_b128 v11, v[40:43] offset:8192
v_perm_b32 v44, v101, v97, s61
v_perm_b32 v45, v109, v105, s61
v_perm_b32 v46, v117, v113, s61
v_perm_b32 v47, v125, v121, s61
ds_write_b128 v11, v[44:47] offset:12288
v_perm_b32 v32, v102, v98, s60
v_perm_b32 v33, v110, v106, s60
v_perm_b32 v34, v118, v114, s60
v_perm_b32 v35, v126, v122, s60
ds_write_b128 v11, v[32:35] offset:16384
v_perm_b32 v36, v102, v98, s61
v_perm_b32 v37, v110, v106, s61
v_perm_b32 v38, v118, v114, s61
v_perm_b32 v39, v126, v122, s61
ds_write_b128 v11, v[36:39] offset:20480
v_perm_b32 v40, v103, v99, s60
v_perm_b32 v41, v111, v107, s60
v_perm_b32 v42, v119, v115, s60
v_perm_b32 v43, v127, v123, s60
ds_write_b128 v11, v[40:43] offset:24576
v_perm_b32 v44, v103, v99, s61
v_perm_b32 v45, v111, v107, s61
v_perm_b32 v46, v119, v115, s61
v_perm_b32 v47, v127, v123, s61
ds_write_b128 v11, v[44:47] offset:28672
s_waitcnt vmcnt(8)
v_perm_b32 v32, v132, v128, s60
v_perm_b32 v33, v140, v136, s60
v_perm_b32 v34, v148, v144, s60
v_perm_b32 v35, v156, v152, s60
ds_write_b128 v9, v[32:35] offset:0
v_perm_b32 v36, v132, v128, s61
v_perm_b32 v37, v140, v136, s61
v_perm_b32 v38, v148, v144, s61
v_perm_b32 v39, v156, v152, s61
ds_write_b128 v9, v[36:39] offset:4096
v_perm_b32 v40, v133, v129, s60
v_perm_b32 v41, v141, v137, s60
v_perm_b32 v42, v149, v145, s60
v_perm_b32 v43, v157, v153, s60
ds_write_b128 v9, v[40:43] offset:8192
v_perm_b32 v44, v133, v129, s61
v_perm_b32 v45, v141, v137, s61
v_perm_b32 v46, v149, v145, s61
v_perm_b32 v47, v157, v153, s61
ds_write_b128 v9, v[44:47] offset:12288
v_perm_b32 v32, v134, v130, s60
v_perm_b32 v33, v142, v138, s60
v_perm_b32 v34, v150, v146, s60
v_perm_b32 v35, v158, v154, s60
ds_write_b128 v9, v[32:35] offset:16384
v_perm_b32 v36, v134, v130, s61
v_perm_b32 v37, v142, v138, s61
v_perm_b32 v38, v150, v146, s61
v_perm_b32 v39, v158, v154, s61
ds_write_b128 v9, v[36:39] offset:20480
v_perm_b32 v40, v135, v131, s60
v_perm_b32 v41, v143, v139, s60
v_perm_b32 v42, v151, v147, s60
v_perm_b32 v43, v159, v155, s60
ds_write_b128 v9, v[40:43] offset:24576
v_perm_b32 v44, v135, v131, s61
v_perm_b32 v45, v143, v139, s61
v_perm_b32 v46, v151, v147, s61
v_perm_b32 v47, v159, v155, s61
ds_write_b128 v9, v[44:47] offset:28672
s_waitcnt vmcnt(0)
v_perm_b32 v32, v164, v160, s60
v_perm_b32 v33, v172, v168, s60
v_perm_b32 v34, v180, v176, s60
v_perm_b32 v35, v188, v184, s60
ds_write_b128 v12, v[32:35] offset:0
v_perm_b32 v36, v164, v160, s61
v_perm_b32 v37, v172, v168, s61
v_perm_b32 v38, v180, v176, s61
v_perm_b32 v39, v188, v184, s61
ds_write_b128 v12, v[36:39] offset:4096
v_perm_b32 v40, v165, v161, s60
v_perm_b32 v41, v173, v169, s60
v_perm_b32 v42, v181, v177, s60
v_perm_b32 v43, v189, v185, s60
ds_write_b128 v12, v[40:43] offset:8192
v_perm_b32 v44, v165, v161, s61
v_perm_b32 v45, v173, v169, s61
v_perm_b32 v46, v181, v177, s61
v_perm_b32 v47, v189, v185, s61
ds_write_b128 v12, v[44:47] offset:12288
v_perm_b32 v32, v166, v162, s60
v_perm_b32 v33, v174, v170, s60
v_perm_b32 v34, v182, v178, s60
v_perm_b32 v35, v190, v186, s60
ds_write_b128 v12, v[32:35] offset:16384
v_perm_b32 v36, v166, v162, s61
v_perm_b32 v37, v174, v170, s61
v_perm_b32 v38, v182, v178, s61
v_perm_b32 v39, v190, v186, s61
ds_write_b128 v12, v[36:39] offset:20480
v_perm_b32 v40, v167, v163, s60
v_perm_b32 v41, v175, v171, s60
v_perm_b32 v42, v183, v179, s60
v_perm_b32 v43, v191, v187, s60
ds_write_b128 v12, v[40:43] offset:24576
v_perm_b32 v44, v167, v163, s61
v_perm_b32 v45, v175, v171, s61
v_perm_b32 v46, v183, v179, s61
v_perm_b32 v47, v191, v187, s61
ds_write_b128 v12, v[44:47] offset:28672
s_waitcnt lgkmcnt(0)
s_barrier
s_endpgm
K1_EDGE:
s_waitcnt lgkmcnt(0)
s_mov_b32 s28, s10
s_mov_b32 s29, s11
s_mov_b32 s30, 75000
s_mov_b32 s31, 0x20000
s_mov_b32 s32, s12
s_mov_b32 s33, s13
s_mov_b32 s34, 1600000
s_mov_b32 s35, 0x20000
s_mov_b32 s36, s14
s_mov_b32 s37, s15
s_mov_b32 s38, 1600000
s_mov_b32 s39, 0x20000
s_add_u32 s22, s20, 16777216
s_addc_u32 s23, s21, 0
s_mov_b32 s40, s22
s_mov_b32 s41, s23
s_mov_b32 s42, 200000
s_mov_b32 s43, 0x20000
s_add_u32 s22, s20, 17825792
s_addc_u32 s23, s21, 0
s_mov_b32 s44, s22
s_mov_b32 s45, s23
s_mov_b32 s46, 1600000
s_mov_b32 s47, 0x20000
v_lshlrev_b32 v3, 4, v0
v_mul_u32_u24 v4, 12, v0
s_mul_i32 s4, s2, 32000
s_mov_b32 s5, 0
buffer_load_dwordx3 v[64:66], v4, s[28:31], s5 offen
s_mov_b32 s5, 6144
buffer_load_dwordx3 v[68:70], v4, s[28:31], s5 offen
s_mov_b32 s5, 12288
buffer_load_dwordx3 v[72:74], v4, s[28:31], s5 offen
s_mov_b32 s5, 18432
buffer_load_dwordx3 v[76:78], v4, s[28:31], s5 offen
s_mov_b32 s5, 24576
buffer_load_dwordx3 v[80:82], v4, s[28:31], s5 offen
s_mov_b32 s5, 30720
buffer_load_dwordx3 v[84:86], v4, s[28:31], s5 offen
s_mov_b32 s5, 36864
buffer_load_dwordx3 v[88:90], v4, s[28:31], s5 offen
s_mov_b32 s5, 43008
buffer_load_dwordx3 v[92:94], v4, s[28:31], s5 offen
s_mov_b32 s5, 49152
buffer_load_dwordx3 v[96:98], v4, s[28:31], s5 offen
s_mov_b32 s5, 55296
buffer_load_dwordx3 v[100:102], v4, s[28:31], s5 offen
s_mov_b32 s5, 61440
buffer_load_dwordx3 v[104:106], v4, s[28:31], s5 offen
s_mov_b32 s5, 67584
buffer_load_dwordx3 v[108:110], v4, s[28:31], s5 offen
s_mov_b32 s5, 73728
buffer_load_dwordx3 v[112:114], v4, s[28:31], s5 offen
s_add_u32 s5, s4, 0
buffer_load_dwordx4 v[16:19], v3, s[32:35], s5 offen
buffer_load_dwordx4 v[32:35], v3, s[36:39], s5 offen
s_add_u32 s5, s4, 8192
buffer_load_dwordx4 v[20:23], v3, s[32:35], s5 offen
buffer_load_dwordx4 v[36:39], v3, s[36:39], s5 offen
s_add_u32 s5, s4, 16384
buffer_load_dwordx4 v[24:27], v3, s[32:35], s5 offen
buffer_load_dwordx4 v[40:43], v3, s[36:39], s5 offen
s_add_u32 s5, s4, 24576
buffer_load_dwordx4 v[28:31], v3, s[32:35], s5 offen
buffer_load_dwordx4 v[44:47], v3, s[36:39], s5 offen
v_mov_b32 v4, -1
v_mov_b32 v5, -1
v_mov_b32 v6, -1
v_mov_b32 v7, -1
v_add_u32 v8, 133120, v3
s_movk_i32 s57, 384
v_cmp_gt_u32 vcc, s57, v0
s_nop 0
s_and_saveexec_b64 s[62:63], vcc
ds_write_b128 v8, v[4:7]
s_mov_b64 exec, s[62:63]
v_mov_b32 v9, 0
v_lshlrev_b32 v10, 2, v0
v_add_u32 v10, 139264, v10
s_movk_i32 s57, 256
v_cmp_gt_u32 vcc, s57, v0
s_nop 0
s_and_saveexec_b64 s[62:63], vcc
ds_write_b32 v10, v9
s_mov_b64 exec, s[62:63]
s_mov_b32 s61, 0xffff0000
s_waitcnt vmcnt(20)
v_mov_b32 v120, v64
v_lshlrev_b32 v121, 16, v65
v_alignbit_b32 v122, v66, v65, 16
v_and_b32 v123, s61, v66
ds_write_b128 v3, v[120:123] offset:0
s_waitcnt vmcnt(19)
v_mov_b32 v124, v68
v_lshlrev_b32 v125, 16, v69
v_alignbit_b32 v126, v70, v69, 16
v_and_b32 v127, s61, v70
ds_write_b128 v3, v[124:127] offset:8192
s_waitcnt vmcnt(18)
v_mov_b32 v120, v72
v_lshlrev_b32 v121, 16, v73
v_alignbit_b32 v122, v74, v73, 16
v_and_b32 v123, s61, v74
ds_write_b128 v3, v[120:123] offset:16384
s_waitcnt vmcnt(17)
v_mov_b32 v124, v76
v_lshlrev_b32 v125, 16, v77
v_alignbit_b32 v126, v78, v77, 16
v_and_b32 v127, s61, v78
ds_write_b128 v3, v[124:127] offset:24576
s_waitcnt vmcnt(16)
v_mov_b32 v120, v80
v_lshlrev_b32 v121, 16, v81
v_alignbit_b32 v122, v82, v81, 16
v_and_b32 v123, s61, v82
ds_write_b128 v3, v[120:123] offset:32768
s_waitcnt vmcnt(15)
v_mov_b32 v124, v84
v_lshlrev_b32 v125, 16, v85
v_alignbit_b32 v126, v86, v85, 16
v_and_b32 v127, s61, v86
ds_write_b128 v3, v[124:127] offset:40960
s_waitcnt vmcnt(14)
v_mov_b32 v120, v88
v_lshlrev_b32 v121, 16, v89
v_alignbit_b32 v122, v90, v89, 16
v_and_b32 v123, s61, v90
ds_write_b128 v3, v[120:123] offset:49152
s_waitcnt vmcnt(13)
v_mov_b32 v124, v92
v_lshlrev_b32 v125, 16, v93
v_alignbit_b32 v126, v94, v93, 16
v_and_b32 v127, s61, v94
ds_write_b128 v3, v[124:127] offset:57344
s_waitcnt vmcnt(12)
v_mov_b32 v120, v96
v_lshlrev_b32 v121, 16, v97
v_alignbit_b32 v122, v98, v97, 16
v_and_b32 v123, s61, v98
v_add_u32 v11, 65536, v3
ds_write_b128 v11, v[120:123]
s_waitcnt vmcnt(11)
v_mov_b32 v124, v100
v_lshlrev_b32 v125, 16, v101
v_alignbit_b32 v126, v102, v101, 16
v_and_b32 v127, s61, v102
v_add_u32 v11, 73728, v3
ds_write_b128 v11, v[124:127]
s_waitcnt vmcnt(10)
v_mov_b32 v120, v104
v_lshlrev_b32 v121, 16, v105
v_alignbit_b32 v122, v106, v105, 16
v_and_b32 v123, s61, v106
v_add_u32 v11, 81920, v3
ds_write_b128 v11, v[120:123]
s_waitcnt vmcnt(9)
v_mov_b32 v124, v108
v_lshlrev_b32 v125, 16, v109
v_alignbit_b32 v126, v110, v109, 16
v_and_b32 v127, s61, v110
v_add_u32 v11, 90112, v3
ds_write_b128 v11, v[124:127]
s_waitcnt vmcnt(8)
v_mov_b32 v120, v112
v_lshlrev_b32 v121, 16, v113
v_alignbit_b32 v122, v114, v113, 16
v_and_b32 v123, s61, v114
v_cmp_gt_u32 vcc, 106, v0
s_nop 0
s_and_saveexec_b64 s[62:63], vcc
v_add_u32 v11, 98304, v3
ds_write_b128 v11, v[120:123]
s_mov_b64 exec, s[62:63]
s_waitcnt lgkmcnt(0)
s_barrier
s_mov_b32 s60, 0x41c20000
s_lshl_b32 s58, s3, 12
s_add_u32 s58, s58, 100352
s_mov_b32 s59, 0
s_waitcnt vmcnt(6)
v_lshlrev_b32 v10, 3, v16
v_lshlrev_b32 v11, 3, v32
ds_read_b64 v[64:65], v10
ds_read_b64 v[66:67], v11
v_lshlrev_b32 v10, 3, v17
v_lshlrev_b32 v11, 3, v33
ds_read_b64 v[68:69], v10
ds_read_b64 v[70:71], v11
v_lshlrev_b32 v10, 3, v18
v_lshlrev_b32 v11, 3, v34
ds_read_b64 v[72:73], v10
ds_read_b64 v[74:75], v11
v_lshlrev_b32 v10, 3, v19
v_lshlrev_b32 v11, 3, v35
ds_read_b64 v[76:77], v10
ds_read_b64 v[78:79], v11
s_waitcnt lgkmcnt(6)
v_lshlrev_b32 v80, 16, v64
v_and_b32 v81, s61, v64
v_lshlrev_b32 v82, 16, v66
v_and_b32 v83, s61, v66
v_sub_f32 v80, v80, v82
v_sub_f32 v81, v81, v83
v_sub_f32 v82, v65, v67
v_mul_f32 v80, v80, v80
v_fmac_f32 v80, v81, v81
v_fmac_f32 v80, v82, v82
v_lshl_or_b32 v84, v32, 14, v16
v_cmp_gt_f32 vcc, s60, v80
s_nop 1
v_mbcnt_lo_u32_b32 v85, vcc_lo, 0
v_mbcnt_hi_u32_b32 v85, vcc_hi, v85
s_lshl_b32 s57, s59, 2
s_add_u32 s57, s57, s58
v_lshl_add_u32 v85, v85, 2, s57
s_bcnt1_i32_b64 s57, vcc
s_add_u32 s59, s59, s57
s_mov_b64 exec, vcc
ds_write_b32 v85, v84
s_mov_b64 exec, -1
s_waitcnt lgkmcnt(4)
v_lshlrev_b32 v80, 16, v68
v_and_b32 v81, s61, v68
v_lshlrev_b32 v82, 16, v70
v_and_b32 v83, s61, v70
v_sub_f32 v80, v80, v82
v_sub_f32 v81, v81, v83
v_sub_f32 v82, v69, v71
v_mul_f32 v80, v80, v80
v_fmac_f32 v80, v81, v81
v_fmac_f32 v80, v82, v82
v_lshl_or_b32 v84, v33, 14, v17
v_cmp_gt_f32 vcc, s60, v80
s_nop 1
v_mbcnt_lo_u32_b32 v85, vcc_lo, 0
v_mbcnt_hi_u32_b32 v85, vcc_hi, v85
s_lshl_b32 s57, s59, 2
s_add_u32 s57, s57, s58
v_lshl_add_u32 v85, v85, 2, s57
s_bcnt1_i32_b64 s57, vcc
s_add_u32 s59, s59, s57
s_mov_b64 exec, vcc
ds_write_b32 v85, v84
s_mov_b64 exec, -1
s_waitcnt lgkmcnt(2)
v_lshlrev_b32 v80, 16, v72
v_and_b32 v81, s61, v72
v_lshlrev_b32 v82, 16, v74
v_and_b32 v83, s61, v74
v_sub_f32 v80, v80, v82
v_sub_f32 v81, v81, v83
v_sub_f32 v82, v73, v75
v_mul_f32 v80, v80, v80
v_fmac_f32 v80, v81, v81
v_fmac_f32 v80, v82, v82
v_lshl_or_b32 v84, v34, 14, v18
v_cmp_gt_f32 vcc, s60, v80
s_nop 1
v_mbcnt_lo_u32_b32 v85, vcc_lo, 0
v_mbcnt_hi_u32_b32 v85, vcc_hi, v85
s_lshl_b32 s57, s59, 2
s_add_u32 s57, s57, s58
v_lshl_add_u32 v85, v85, 2, s57
s_bcnt1_i32_b64 s57, vcc
s_add_u32 s59, s59, s57
s_mov_b64 exec, vcc
ds_write_b32 v85, v84
s_mov_b64 exec, -1
s_waitcnt lgkmcnt(0)
v_lshlrev_b32 v80, 16, v76
v_and_b32 v81, s61, v76
v_lshlrev_b32 v82, 16, v78
v_and_b32 v83, s61, v78
v_sub_f32 v80, v80, v82
v_sub_f32 v81, v81, v83
v_sub_f32 v82, v77, v79
v_mul_f32 v80, v80, v80
v_fmac_f32 v80, v81, v81
v_fmac_f32 v80, v82, v82
v_lshl_or_b32 v84, v35, 14, v19
v_cmp_gt_f32 vcc, s60, v80
s_nop 1
v_mbcnt_lo_u32_b32 v85, vcc_lo, 0
v_mbcnt_hi_u32_b32 v85, vcc_hi, v85
s_lshl_b32 s57, s59, 2
s_add_u32 s57, s57, s58
v_lshl_add_u32 v85, v85, 2, s57
s_bcnt1_i32_b64 s57, vcc
s_add_u32 s59, s59, s57
s_mov_b64 exec, vcc
ds_write_b32 v85, v84
s_mov_b64 exec, -1
s_waitcnt vmcnt(4)
v_lshlrev_b32 v10, 3, v20
v_lshlrev_b32 v11, 3, v36
ds_read_b64 v[64:65], v10
ds_read_b64 v[66:67], v11
v_lshlrev_b32 v10, 3, v21
v_lshlrev_b32 v11, 3, v37
ds_read_b64 v[68:69], v10
ds_read_b64 v[70:71], v11
v_lshlrev_b32 v10, 3, v22
v_lshlrev_b32 v11, 3, v38
ds_read_b64 v[72:73], v10
ds_read_b64 v[74:75], v11
v_lshlrev_b32 v10, 3, v23
v_lshlrev_b32 v11, 3, v39
ds_read_b64 v[76:77], v10
ds_read_b64 v[78:79], v11
s_waitcnt lgkmcnt(6)
v_lshlrev_b32 v80, 16, v64
v_and_b32 v81, s61, v64
v_lshlrev_b32 v82, 16, v66
v_and_b32 v83, s61, v66
v_sub_f32 v80, v80, v82
v_sub_f32 v81, v81, v83
v_sub_f32 v82, v65, v67
v_mul_f32 v80, v80, v80
v_fmac_f32 v80, v81, v81
v_fmac_f32 v80, v82, v82
v_lshl_or_b32 v84, v36, 14, v20
v_cmp_gt_f32 vcc, s60, v80
s_nop 1
v_mbcnt_lo_u32_b32 v85, vcc_lo, 0
v_mbcnt_hi_u32_b32 v85, vcc_hi, v85
s_lshl_b32 s57, s59, 2
s_add_u32 s57, s57, s58
v_lshl_add_u32 v85, v85, 2, s57
s_bcnt1_i32_b64 s57, vcc
s_add_u32 s59, s59, s57
s_mov_b64 exec, vcc
ds_write_b32 v85, v84
s_mov_b64 exec, -1
s_waitcnt lgkmcnt(4)
v_lshlrev_b32 v80, 16, v68
v_and_b32 v81, s61, v68
v_lshlrev_b32 v82, 16, v70
v_and_b32 v83, s61, v70
v_sub_f32 v80, v80, v82
v_sub_f32 v81, v81, v83
v_sub_f32 v82, v69, v71
v_mul_f32 v80, v80, v80
v_fmac_f32 v80, v81, v81
v_fmac_f32 v80, v82, v82
v_lshl_or_b32 v84, v37, 14, v21
v_cmp_gt_f32 vcc, s60, v80
s_nop 1
v_mbcnt_lo_u32_b32 v85, vcc_lo, 0
v_mbcnt_hi_u32_b32 v85, vcc_hi, v85
s_lshl_b32 s57, s59, 2
s_add_u32 s57, s57, s58
v_lshl_add_u32 v85, v85, 2, s57
s_bcnt1_i32_b64 s57, vcc
s_add_u32 s59, s59, s57
s_mov_b64 exec, vcc
ds_write_b32 v85, v84
s_mov_b64 exec, -1
s_waitcnt lgkmcnt(2)
v_lshlrev_b32 v80, 16, v72
v_and_b32 v81, s61, v72
v_lshlrev_b32 v82, 16, v74
v_and_b32 v83, s61, v74
v_sub_f32 v80, v80, v82
v_sub_f32 v81, v81, v83
v_sub_f32 v82, v73, v75
v_mul_f32 v80, v80, v80
v_fmac_f32 v80, v81, v81
v_fmac_f32 v80, v82, v82
v_lshl_or_b32 v84, v38, 14, v22
v_cmp_gt_f32 vcc, s60, v80
s_nop 1
v_mbcnt_lo_u32_b32 v85, vcc_lo, 0
v_mbcnt_hi_u32_b32 v85, vcc_hi, v85
s_lshl_b32 s57, s59, 2
s_add_u32 s57, s57, s58
v_lshl_add_u32 v85, v85, 2, s57
s_bcnt1_i32_b64 s57, vcc
s_add_u32 s59, s59, s57
s_mov_b64 exec, vcc
ds_write_b32 v85, v84
s_mov_b64 exec, -1
s_waitcnt lgkmcnt(0)
v_lshlrev_b32 v80, 16, v76
v_and_b32 v81, s61, v76
v_lshlrev_b32 v82, 16, v78
v_and_b32 v83, s61, v78
v_sub_f32 v80, v80, v82
v_sub_f32 v81, v81, v83
v_sub_f32 v82, v77, v79
v_mul_f32 v80, v80, v80
v_fmac_f32 v80, v81, v81
v_fmac_f32 v80, v82, v82
v_lshl_or_b32 v84, v39, 14, v23
v_cmp_gt_f32 vcc, s60, v80
s_nop 1
v_mbcnt_lo_u32_b32 v85, vcc_lo, 0
v_mbcnt_hi_u32_b32 v85, vcc_hi, v85
s_lshl_b32 s57, s59, 2
s_add_u32 s57, s57, s58
v_lshl_add_u32 v85, v85, 2, s57
s_bcnt1_i32_b64 s57, vcc
s_add_u32 s59, s59, s57
s_mov_b64 exec, vcc
ds_write_b32 v85, v84
s_mov_b64 exec, -1
s_waitcnt vmcnt(2)
v_lshlrev_b32 v10, 3, v24
v_lshlrev_b32 v11, 3, v40
ds_read_b64 v[64:65], v10
ds_read_b64 v[66:67], v11
v_lshlrev_b32 v10, 3, v25
v_lshlrev_b32 v11, 3, v41
ds_read_b64 v[68:69], v10
ds_read_b64 v[70:71], v11
v_lshlrev_b32 v10, 3, v26
v_lshlrev_b32 v11, 3, v42
ds_read_b64 v[72:73], v10
ds_read_b64 v[74:75], v11
v_lshlrev_b32 v10, 3, v27
v_lshlrev_b32 v11, 3, v43
ds_read_b64 v[76:77], v10
ds_read_b64 v[78:79], v11
s_waitcnt lgkmcnt(6)
v_lshlrev_b32 v80, 16, v64
v_and_b32 v81, s61, v64
v_lshlrev_b32 v82, 16, v66
v_and_b32 v83, s61, v66
v_sub_f32 v80, v80, v82
v_sub_f32 v81, v81, v83
v_sub_f32 v82, v65, v67
v_mul_f32 v80, v80, v80
v_fmac_f32 v80, v81, v81
v_fmac_f32 v80, v82, v82
v_lshl_or_b32 v84, v40, 14, v24
v_cmp_gt_f32 vcc, s60, v80
s_nop 1
v_mbcnt_lo_u32_b32 v85, vcc_lo, 0
v_mbcnt_hi_u32_b32 v85, vcc_hi, v85
s_lshl_b32 s57, s59, 2
s_add_u32 s57, s57, s58
v_lshl_add_u32 v85, v85, 2, s57
s_bcnt1_i32_b64 s57, vcc
s_add_u32 s59, s59, s57
s_mov_b64 exec, vcc
ds_write_b32 v85, v84
s_mov_b64 exec, -1
s_waitcnt lgkmcnt(4)
v_lshlrev_b32 v80, 16, v68
v_and_b32 v81, s61, v68
v_lshlrev_b32 v82, 16, v70
v_and_b32 v83, s61, v70
v_sub_f32 v80, v80, v82
v_sub_f32 v81, v81, v83
v_sub_f32 v82, v69, v71
v_mul_f32 v80, v80, v80
v_fmac_f32 v80, v81, v81
v_fmac_f32 v80, v82, v82
v_lshl_or_b32 v84, v41, 14, v25
v_cmp_gt_f32 vcc, s60, v80
s_nop 1
v_mbcnt_lo_u32_b32 v85, vcc_lo, 0
v_mbcnt_hi_u32_b32 v85, vcc_hi, v85
s_lshl_b32 s57, s59, 2
s_add_u32 s57, s57, s58
v_lshl_add_u32 v85, v85, 2, s57
s_bcnt1_i32_b64 s57, vcc
s_add_u32 s59, s59, s57
s_mov_b64 exec, vcc
ds_write_b32 v85, v84
s_mov_b64 exec, -1
s_waitcnt lgkmcnt(2)
v_lshlrev_b32 v80, 16, v72
v_and_b32 v81, s61, v72
v_lshlrev_b32 v82, 16, v74
v_and_b32 v83, s61, v74
v_sub_f32 v80, v80, v82
v_sub_f32 v81, v81, v83
v_sub_f32 v82, v73, v75
v_mul_f32 v80, v80, v80
v_fmac_f32 v80, v81, v81
v_fmac_f32 v80, v82, v82
v_lshl_or_b32 v84, v42, 14, v26
v_cmp_gt_f32 vcc, s60, v80
s_nop 1
v_mbcnt_lo_u32_b32 v85, vcc_lo, 0
v_mbcnt_hi_u32_b32 v85, vcc_hi, v85
s_lshl_b32 s57, s59, 2
s_add_u32 s57, s57, s58
v_lshl_add_u32 v85, v85, 2, s57
s_bcnt1_i32_b64 s57, vcc
s_add_u32 s59, s59, s57
s_mov_b64 exec, vcc
ds_write_b32 v85, v84
s_mov_b64 exec, -1
s_waitcnt lgkmcnt(0)
v_lshlrev_b32 v80, 16, v76
v_and_b32 v81, s61, v76
v_lshlrev_b32 v82, 16, v78
v_and_b32 v83, s61, v78
v_sub_f32 v80, v80, v82
v_sub_f32 v81, v81, v83
v_sub_f32 v82, v77, v79
v_mul_f32 v80, v80, v80
v_fmac_f32 v80, v81, v81
v_fmac_f32 v80, v82, v82
v_lshl_or_b32 v84, v43, 14, v27
v_cmp_gt_f32 vcc, s60, v80
s_nop 1
v_mbcnt_lo_u32_b32 v85, vcc_lo, 0
v_mbcnt_hi_u32_b32 v85, vcc_hi, v85
s_lshl_b32 s57, s59, 2
s_add_u32 s57, s57, s58
v_lshl_add_u32 v85, v85, 2, s57
s_bcnt1_i32_b64 s57, vcc
s_add_u32 s59, s59, s57
s_mov_b64 exec, vcc
ds_write_b32 v85, v84
s_mov_b64 exec, -1
s_waitcnt vmcnt(0)
v_lshlrev_b32 v10, 3, v28
v_lshlrev_b32 v11, 3, v44
ds_read_b64 v[64:65], v10
ds_read_b64 v[66:67], v11
v_lshlrev_b32 v10, 3, v29
v_lshlrev_b32 v11, 3, v45
ds_read_b64 v[68:69], v10
ds_read_b64 v[70:71], v11
v_lshlrev_b32 v10, 3, v30
v_lshlrev_b32 v11, 3, v46
ds_read_b64 v[72:73], v10
ds_read_b64 v[74:75], v11
v_lshlrev_b32 v10, 3, v31
v_lshlrev_b32 v11, 3, v47
ds_read_b64 v[76:77], v10
ds_read_b64 v[78:79], v11
s_mov_b32 s57, 464
v_cmp_gt_u32 s[62:63], s57, v0
s_waitcnt lgkmcnt(6)
v_lshlrev_b32 v80, 16, v64
v_and_b32 v81, s61, v64
v_lshlrev_b32 v82, 16, v66
v_and_b32 v83, s61, v66
v_sub_f32 v80, v80, v82
v_sub_f32 v81, v81, v83
v_sub_f32 v82, v65, v67
v_mul_f32 v80, v80, v80
v_fmac_f32 v80, v81, v81
v_fmac_f32 v80, v82, v82
v_lshl_or_b32 v84, v44, 14, v28
v_cmp_gt_f32 vcc, s60, v80
s_nop 0
s_and_b64 vcc, vcc, s[62:63]
v_mbcnt_lo_u32_b32 v85, vcc_lo, 0
v_mbcnt_hi_u32_b32 v85, vcc_hi, v85
s_lshl_b32 s57, s59, 2
s_add_u32 s57, s57, s58
v_lshl_add_u32 v85, v85, 2, s57
s_bcnt1_i32_b64 s57, vcc
s_add_u32 s59, s59, s57
s_mov_b64 exec, vcc
ds_write_b32 v85, v84
s_mov_b64 exec, -1
s_waitcnt lgkmcnt(4)
v_lshlrev_b32 v80, 16, v68
v_and_b32 v81, s61, v68
v_lshlrev_b32 v82, 16, v70
v_and_b32 v83, s61, v70
v_sub_f32 v80, v80, v82
v_sub_f32 v81, v81, v83
v_sub_f32 v82, v69, v71
v_mul_f32 v80, v80, v80
v_fmac_f32 v80, v81, v81
v_fmac_f32 v80, v82, v82
v_lshl_or_b32 v84, v45, 14, v29
v_cmp_gt_f32 vcc, s60, v80
s_nop 0
s_and_b64 vcc, vcc, s[62:63]
v_mbcnt_lo_u32_b32 v85, vcc_lo, 0
v_mbcnt_hi_u32_b32 v85, vcc_hi, v85
s_lshl_b32 s57, s59, 2
s_add_u32 s57, s57, s58
v_lshl_add_u32 v85, v85, 2, s57
s_bcnt1_i32_b64 s57, vcc
s_add_u32 s59, s59, s57
s_mov_b64 exec, vcc
ds_write_b32 v85, v84
s_mov_b64 exec, -1
s_waitcnt lgkmcnt(2)
v_lshlrev_b32 v80, 16, v72
v_and_b32 v81, s61, v72
v_lshlrev_b32 v82, 16, v74
v_and_b32 v83, s61, v74
v_sub_f32 v80, v80, v82
v_sub_f32 v81, v81, v83
v_sub_f32 v82, v73, v75
v_mul_f32 v80, v80, v80
v_fmac_f32 v80, v81, v81
v_fmac_f32 v80, v82, v82
v_lshl_or_b32 v84, v46, 14, v30
v_cmp_gt_f32 vcc, s60, v80
s_nop 0
s_and_b64 vcc, vcc, s[62:63]
v_mbcnt_lo_u32_b32 v85, vcc_lo, 0
v_mbcnt_hi_u32_b32 v85, vcc_hi, v85
s_lshl_b32 s57, s59, 2
s_add_u32 s57, s57, s58
v_lshl_add_u32 v85, v85, 2, s57
s_bcnt1_i32_b64 s57, vcc
s_add_u32 s59, s59, s57
s_mov_b64 exec, vcc
ds_write_b32 v85, v84
s_mov_b64 exec, -1
s_waitcnt lgkmcnt(0)
v_lshlrev_b32 v80, 16, v76
v_and_b32 v81, s61, v76
v_lshlrev_b32 v82, 16, v78
v_and_b32 v83, s61, v78
v_sub_f32 v80, v80, v82
v_sub_f32 v81, v81, v83
v_sub_f32 v82, v77, v79
v_mul_f32 v80, v80, v80
v_fmac_f32 v80, v81, v81
v_fmac_f32 v80, v82, v82
v_lshl_or_b32 v84, v47, 14, v31
v_cmp_gt_f32 vcc, s60, v80
s_nop 0
s_and_b64 vcc, vcc, s[62:63]
v_mbcnt_lo_u32_b32 v85, vcc_lo, 0
v_mbcnt_hi_u32_b32 v85, vcc_hi, v85
s_lshl_b32 s57, s59, 2
s_add_u32 s57, s57, s58
v_lshl_add_u32 v85, v85, 2, s57
s_bcnt1_i32_b64 s57, vcc
s_add_u32 s59, s59, s57
s_mov_b64 exec, vcc
ds_write_b32 v85, v84
s_mov_b64 exec, -1
s_mov_b32 s56, 0
v_mov_b32 v9, 1
s_mul_i32 s55, s2, 32000
s_waitcnt lgkmcnt(0)
K1_QLOOP:
s_cmp_ge_u32 s56, s59
s_cbranch_scc1 K1_QDONE
s_sub_u32 s57, s59, s56
v_cmp_gt_u32 vcc, s57, v1
s_nop 0
s_mov_b64 exec, vcc
s_lshl_b32 s57, s56, 2
s_add_u32 s57, s57, s58
v_lshl_add_u32 v10, v1, 2, s57
ds_read_b32 v84, v10
s_waitcnt lgkmcnt(0)
v_and_b32 v85, 0x3fff, v84
v_lshrrev_b32 v86, 14, v84
v_lshlrev_b32 v10, 3, v85
v_lshlrev_b32 v11, 3, v86
ds_read_b64 v[64:65], v10
ds_read_b64 v[66:67], v11
v_mul_u32_u24 v12, 5243, v86
v_lshrrev_b32 v12, 19, v12
v_mul_u32_u24 v13, 100, v12
v_sub_u32 v13, v86, v13
v_lshlrev_b32 v14, 2, v12
v_add_u32 v14, 139264, v14
s_waitcnt lgkmcnt(0)
v_lshlrev_b32 v80, 16, v64
v_and_b32 v81, s61, v64
v_lshlrev_b32 v82, 16, v66
v_and_b32 v83, s61, v66
v_sub_f32 v80, v80, v82
v_sub_f32 v81, v81, v83
v_sub_f32 v82, v65, v67
v_cvt_pk_bf16_f32 v68, v80, v81
v_cvt_pk_bf16_f32 v69, v82, v82
v_lshlrev_b32 v80, 16, v68
v_and_b32 v81, s61, v68
v_lshlrev_b32 v82, 16, v69
v_mul_f32 v80, v80, v80
v_mul_f32 v81, v81, v81
v_mul_f32 v82, v82, v82
v_cvt_pk_bf16_f32 v70, v80, v81
v_cvt_pk_bf16_f32 v71, v82, v82
v_lshlrev_b32 v80, 16, v70
v_and_b32 v81, s61, v70
v_lshlrev_b32 v82, 16, v71
v_add_f32 v80, v80, v81
v_add_f32 v80, v80, v82
s_mov_b32 s57, 0x41bf8000
v_cmp_gt_f32 vcc, s57, v80
s_nop 0
s_and_b64 exec, exec, vcc
ds_add_rtn_u32 v15, v14, v9
v_and_b32 v69, 0xffff, v69
v_lshl_or_b32 v69, v85, 16, v69
s_waitcnt lgkmcnt(0)
v_cmp_gt_u32 vcc, 31, v15
v_min_u32 v15, 31, v15
v_mov_b32 v16, 0xfe
v_cndmask_b32 v13, v16, v13, vcc
v_mul_u32_u24 v16, 32, v12
v_add_u32 v16, v16, v15
v_add_u32 v17, 133120, v16
ds_write_b8 v17, v13
v_lshlrev_b32 v16, 3, v16
s_and_b64 exec, exec, vcc
buffer_store_dwordx2 v[68:69], v16, s[44:47], s55 offen
s_mov_b64 exec, -1
s_add_u32 s56, s56, 64
s_branch K1_QLOOP
K1_QDONE:
s_mov_b64 exec, -1
s_waitcnt lgkmcnt(0)
s_barrier
s_movk_i32 s57, 250
v_cmp_gt_u32 vcc, s57, v0
s_nop 0
s_and_saveexec_b64 s[62:63], vcc
s_cbranch_execz K1_EDONE
ds_read_b128 v[16:19], v8
s_mul_i32 s4, s2, 4000
s_waitcnt lgkmcnt(0)
buffer_store_dwordx4 v[16:19], v3, s[40:43], s4 offen
K1_EDONE:
K1_END:
s_endpgm
.globl painn_k2_kernel
.p2align 8
.type painn_k2_kernel,@function
painn_k2_kernel:
s_cmp_ge_u32 s2, 256
s_cbranch_scc1 K2_END
s_and_b32 s4, s2, 7
s_and_b32 s5, s4, 1
s_lshr_b32 s4, s4, 1
s_lshl_b32 s4, s4, 5
s_lshr_b32 s6, s2, 3
s_add_u32 s4, s4, s6
s_cmp_ge_u32 s4, 125
s_cbranch_scc1 K2_END
s_load_dwordx2 s[20:21], s[0:1], 80
s_load_dwordx2 s[8:9], s[0:1], 0
s_load_dwordx2 s[16:17], s[0:1], 32
s_load_dwordx4 s[68:71], s[0:1], 56
v_lshrrev_b32 v1, 6, v0
s_nop 0
v_readfirstlane_b32 s3, v1
v_and_b32 v1, 63, v0
v_and_b32 v2, 31, v1
v_lshrrev_b32 v3, 5, v1
v_lshrrev_b32 v4, 3, v0
v_and_b32 v5, 7, v0
v_mul_u32_u24 v6, 4000, v4
v_lshl_add_u32 v6, v5, 2, v6
v_mul_u32_u24 v7, 32000, v4
v_lshl_add_u32 v7, v5, 5, v7
s_mul_i32 s7, s4, 32
s_mul_i32 s6, s4, 256
s_mov_b32 s52, 400
v_cmp_gt_u32 s[62:63], s52, v0
v_mov_b32 v116, -1
s_waitcnt lgkmcnt(0)
s_add_u32 s22, s20, 16777216
s_addc_u32 s23, s21, 0
s_mov_b32 s36, s22
s_mov_b32 s37, s23
s_mov_b32 s38, 200000
s_mov_b32 s39, 0x20000
s_add_u32 s22, s20, 17825792
s_addc_u32 s23, s21, 0
s_mov_b32 s28, s22
s_mov_b32 s29, s23
s_mov_b32 s30, 1600000
s_mov_b32 s31, 0x20000
s_mov_b64 exec, s[62:63]
s_cbranch_execz K2_NOCELL
buffer_load_dword v116, v6, s[36:39], s7 offen
buffer_load_dwordx4 v[56:59], v7, s[28:31], s6 offen
buffer_load_dwordx4 v[60:63], v7, s[28:31], s6 offen offset:16
K2_NOCELL:
s_mov_b64 exec, -1
s_mov_b32 s40, s16
s_mov_b32 s41, s17
s_mov_b32 s42, 8
s_mov_b32 s43, 0x20000
s_mov_b32 s56, s8
s_mov_b32 s57, s9
s_mov_b32 s58, 12800000
s_mov_b32 s59, 0x20000
s_mov_b32 s72, s68
s_mov_b32 s73, s69
s_mov_b32 s74, 3072
s_mov_b32 s75, 0x20000
s_mov_b32 s24, s70
s_mov_b32 s25, s71
s_mov_b32 s26, 12800000
s_mov_b32 s27, 0x20000
s_mul_i32 s7, s5, 8000000
s_add_u32 s22, s20, s7
s_addc_u32 s23, s21, 0
s_mov_b32 s32, s22
s_mov_b32 s33, s23
s_mov_b32 s34, 8000000
s_mov_b32 s35, 0x20000
v_lshrrev_b32 v8, 5, v1
v_lshlrev_b32 v8, 10, v8
v_lshrrev_b32 v9, 3, v1
v_and_b32 v9, 3, v9
v_lshl_add_u32 v8, v9, 8, v8
v_and_b32 v9, 7, v1
v_lshl_add_u32 v8, v9, 4, v8
s_mul_i32 s52, s4, 102400
s_lshl_b32 s53, s5, 7
s_add_u32 s52, s52, s53
s_lshl_b32 s54, s3, 11
s_add_u32 s52, s52, s54
s_lshl_b32 s54, s3, 10
v_and_b32 v10, 15, v2
v_lshlrev_b32 v10, 1, v10
v_lshrrev_b32 v11, 4, v2
v_add_u32 v10, v10, v11
v_lshlrev_b32 v10, 2, v10
s_cmp_lg_u32 s3, 15
s_cbranch_scc1 K2_NOWL
buffer_load_dword v16, v10, s[72:75], s53 offen offset:0
buffer_load_dword v17, v10, s[72:75], s53 offen offset:768
buffer_load_dword v18, v10, s[72:75], s53 offen offset:1536
buffer_load_dword v19, v10, s[72:75], s53 offen offset:2304
buffer_load_dword v20, v10, s[72:75], s53 offen offset:256
buffer_load_dword v21, v10, s[72:75], s53 offen offset:1024
buffer_load_dword v22, v10, s[72:75], s53 offen offset:1792
buffer_load_dword v23, v10, s[72:75], s53 offen offset:2560
buffer_load_dword v24, v10, s[72:75], s53 offen offset:512
buffer_load_dword v25, v10, s[72:75], s53 offen offset:1280
buffer_load_dword v26, v10, s[72:75], s53 offen offset:2048
buffer_load_dword v27, v10, s[72:75], s53 offen offset:2816
v_mov_b32 v11, 0
buffer_load_dwordx2 v[118:119], v11, s[40:43], 0 offen
K2_NOWL:
s_mov_b32 s49, s52
v_lshlrev_b32 v9, 2, v0
s_mov_b32 s52, 2147483648
v_mov_b32 v10, s52
v_mov_b32 v12, 0
v_mov_b32 v13, -1
v_add_u32 v14, 97792, v9
ds_write_b32 v14, v10
v_lshlrev_b32 v11, 3, v0
v_add_u32 v15, 88576, v11
ds_write_b64 v15, v[12:13]
s_movk_i32 s52, 192
v_cmp_gt_u32 vcc, s52, v0
s_nop 0
s_and_saveexec_b64 s[62:63], vcc
ds_write_b32 v14, v10 offset:4096
s_mov_b64 exec, s[62:63]
s_movk_i32 s52, 128
v_cmp_gt_u32 vcc, s52, v0
s_nop 0
s_and_saveexec_b64 s[62:63], vcc
ds_write_b64 v15, v[12:13] offset:8192
ds_write_b32 v14, v12 offset:4864
s_mov_b64 exec, s[62:63]
s_movk_i32 s52, 704
v_cmp_gt_u32 vcc, s52, v0
s_nop 0
s_and_saveexec_b64 s[62:63], vcc
ds_write_b32 v14, v12 offset:5376
s_mov_b64 exec, s[62:63]
s_movk_i32 s52, 16
v_cmp_gt_u32 vcc, s52, v0
s_nop 0
s_and_saveexec_b64 s[62:63], vcc
v_add_u32 v15, 106496, v11
v_mov_b32 v12, 0x7fff
v_mov_b32 v13, 0
ds_write_b64 v15, v[12:13]
v_mov_b32 v12, 0
s_mov_b64 exec, s[62:63]
s_mov_b32 s61, 0xffff0000
v_mov_b32 v9, 1
s_mov_b32 s46, 102656
s_waitcnt lgkmcnt(0)
s_barrier
s_cmp_lt_u32 s3, 7
s_cbranch_scc1 K2_NODMA
s_cmp_eq_u32 s3, 15
s_cbranch_scc1 K2_NODMA
s_sub_u32 s53, s3, 7
s_lshl_b32 s54, s3, 11
s_sub_u32 s49, s49, s54
s_lshl_b32 s54, s53, 11
s_add_u32 s49, s49, s54
s_lshl_b32 s54, s53, 10
s_add_u32 s55, s54, 0
s_mov_b32 m0, s55
s_add_u32 s55, s49, 0
buffer_load_dwordx4 v8, s[56:59], s55 offen lds
s_add_u32 s55, s54, 8192
s_mov_b32 m0, s55
s_add_u32 s55, s49, 16384
buffer_load_dwordx4 v8, s[56:59], s55 offen lds
s_add_u32 s55, s54, 16384
s_mov_b32 m0, s55
s_add_u32 s55, s49, 32768
buffer_load_dwordx4 v8, s[56:59], s55 offen lds
s_add_u32 s55, s54, 24576
s_mov_b32 m0, s55
s_add_u32 s55, s49, 49152
buffer_load_dwordx4 v8, s[56:59], s55 offen lds
s_add_u32 s55, s54, 32768
s_mov_b32 m0, s55
s_add_u32 s55, s49, 65536
buffer_load_dwordx4 v8, s[56:59], s55 offen lds
s_add_u32 s55, s54, 40960
s_mov_b32 m0, s55
s_add_u32 s55, s49, 81920
buffer_load_dwordx4 v8, s[56:59], s55 offen lds
s_cmp_gt_u32 s53, 1
s_cbranch_scc1 K2_NODMA
s_add_u32 s55, s54, 49152
s_mov_b32 m0, s55
s_add_u32 s55, s49, 98304
buffer_load_dwordx4 v8, s[56:59], s55 offen lds
K2_NODMA:
s_cmp_lg_u32 s3, 15
s_cbranch_scc1 K2_NOWW
s_waitcnt vmcnt(0)
v_mov_b32 v10, 105736
ds_write_b64 v10, v[118:119]
v_mul_u32_u24 v10, 48, v2
v_add_u32 v10, 107008, v10
s_mov_b32 exec_hi, 0
ds_write_b128 v10, v[16:19]
ds_write_b128 v10, v[20:23] offset:16
ds_write_b128 v10, v[24:27] offset:32
s_mov_b64 exec, -1
s_waitcnt lgkmcnt(0)
K2_NOWW:
s_cmp_gt_u32 s3, 6
s_cbranch_scc1 K2_S1DONE
s_waitcnt vmcnt(2)
s_movk_i32 s59, 100
v_bfe_u32 v120, v116, 0, 8
v_cmp_gt_u32 s[64:65], s59, v120
v_bfe_u32 v121, v116, 8, 8
v_cmp_gt_u32 s[66:67], s59, v121
v_bfe_u32 v122, v116, 16, 8
v_cmp_gt_u32 s[68:69], s59, v122
v_bfe_u32 v123, v116, 24, 8
v_cmp_gt_u32 s[70:71], s59, v123
v_lshrrev_b32 v10, 24, v116
s_movk_i32 s52, 0xfe
v_cmp_eq_u32 vcc, s52, v10
s_nop 0
s_mov_b64 exec, vcc
v_mov_b32 v10, 105728
ds_write_b32 v10, v9
s_mov_b64 exec, s[64:65]
v_lshl_add_u32 v10, v120, 2, s46
ds_add_rtn_u32 v124, v10, v9
s_mov_b64 exec, s[66:67]
v_lshl_add_u32 v10, v121, 2, s46
ds_add_rtn_u32 v125, v10, v9
s_mov_b64 exec, s[68:69]
v_lshl_add_u32 v10, v122, 2, s46
ds_add_rtn_u32 v126, v10, v9
s_mov_b64 exec, s[70:71]
v_lshl_add_u32 v10, v123, 2, s46
ds_add_rtn_u32 v127, v10, v9
s_mov_b64 exec, -1
s_waitcnt lgkmcnt(0)
K2_S1DONE:
s_barrier
s_cmp_lg_u32 s3, 15
s_cbranch_scc1 K2_NOSCAN
v_lshl_add_u32 v9, v1, 3, s46
ds_read_b64 v[10:11], v9
s_waitcnt lgkmcnt(0)
v_add_u32 v10, 1, v10
v_lshrrev_b32 v10, 1, v10
v_max_u32 v10, 1, v10
v_add_u32 v11, 1, v11
v_lshrrev_b32 v11, 1, v11
v_max_u32 v11, 1, v11
v_cmp_gt_u32 vcc, 50, v1
s_nop 1
v_cndmask_b32 v10, 0, v10, vcc
v_cndmask_b32 v11, 0, v11, vcc
v_add_u32 v12, v10, v11
v_mov_b32 v14, v12
s_nop 1
v_add_u32_dpp v14, v14, v14 row_shr:1 row_mask:0xf bank_mask:0xf bound_ctrl:0
s_nop 1
v_add_u32_dpp v14, v14, v14 row_shr:2 row_mask:0xf bank_mask:0xf bound_ctrl:0
s_nop 1
v_add_u32_dpp v14, v14, v14 row_shr:4 row_mask:0xf bank_mask:0xf bound_ctrl:0
s_nop 1
v_add_u32_dpp v14, v14, v14 row_shr:8 row_mask:0xf bank_mask:0xf bound_ctrl:0
s_nop 1
v_add_u32_dpp v14, v14, v14 row_bcast:15 row_mask:0xa bank_mask:0xf
s_nop 1
v_add_u32_dpp v14, v14, v14 row_bcast:31 row_mask:0xc bank_mask:0xf
s_nop 0
v_readlane_b32 s60, v14, 63
v_sub_u32 v100, v14, v12
v_add_u32 v101, v100, v10
s_cmp_gt_u32 s60, 512
s_cbranch_scc1 K2_PUBT
v_cvt_f32_u32 v13, s60
v_rcp_f32 v13, v13
s_mov_b32 s54, 0x41800000
v_mul_f32 v13, s54, v13
v_cvt_f32_u32 v102, v100
v_cvt_f32_u32 v103, v101
v_mul_f32 v102, v102, v13
v_mul_f32 v103, v103, v13
v_cvt_u32_f32 v102, v102
v_cvt_u32_f32 v103, v103
v_min_u32 v102, 15, v102
v_min_u32 v103, 15, v103
v_lshl_add_u32 v104, v102, 2, v101
v_lshl_add_u32 v100, v102, 2, v100
v_lshl_add_u32 v101, v103, 2, v101
v_lshl_add_u32 v14, v103, 2, v14
s_mov_b32 s52, 105984
v_lshl_add_u32 v9, v1, 3, s52
ds_write_b64 v9, v[100:101]
s_and_saveexec_b64 s[62:63], vcc
s_mov_b32 s52, 103164
v_lshl_add_u32 v10, v104, 2, s52
v_mov_b32 v13, 1
ds_write_b32 v10, v13
v_lshl_add_u32 v10, v14, 2, s52
ds_write_b32 v10, v13
s_mov_b32 s52, 106496
v_lshlrev_b32 v10, 1, v1
v_lshl_add_u32 v11, v102, 3, s52
ds_min_u32 v11, v10
v_add_u32 v12, 1, v10
ds_max_u32 v11, v12 offset:4
v_lshl_add_u32 v11, v103, 3, s52
ds_min_u32 v11, v12
v_add_u32 v12, 2, v10
ds_max_u32 v11, v12 offset:4
s_mov_b64 exec, s[62:63]
K2_PUBT:
v_mov_b32 v10, 105732
v_mov_b32 v11, s60
ds_write_b32 v10, v11
K2_NOSCAN:
s_waitcnt lgkmcnt(0)
s_barrier
v_mov_b32 v10, 105728
ds_read_b64 v[12:13], v10
s_lshl_b32 s52, s3, 3
s_add_u32 s52, s52, 106496
v_mov_b32 v10, s52
ds_read_b64 v[14:15], v10
s_cmp_gt_u32 s3, 6
s_cbranch_scc1 K2_NOST
s_mov_b32 s52, 105984
s_mov_b64 exec, s[64:65]
v_lshl_add_u32 v10, v120, 2, s52
ds_read_b32 v108, v10
s_mov_b64 exec, s[66:67]
v_lshl_add_u32 v10, v121, 2, s52
ds_read_b32 v109, v10
s_mov_b64 exec, s[68:69]
v_lshl_add_u32 v10, v122, 2, s52
ds_read_b32 v110, v10
s_mov_b64 exec, s[70:71]
v_lshl_add_u32 v10, v123, 2, s52
ds_read_b32 v111, v10
s_mov_b64 exec, -1
K2_NOST:
s_waitcnt lgkmcnt(0)
v_readfirstlane_b32 s53, v12
v_readfirstlane_b32 s60, v13
v_readfirstlane_b32 s50, v14
v_readfirstlane_b32 s57, v15
s_cmp_gt_u32 s60, 512
s_cbranch_scc1 K2_SLOW
s_cmp_lg_u32 s53, 0
s_cbranch_scc1 K2_SLOW
s_cmp_eq_u32 s57, 0
s_cselect_b32 s50, 0, s50
s_lshl_b32 s52, s50, 2
s_add_u32 s52, s52, 105984
v_mov_b32 v10, s52
ds_read_b32 v11, v10
s_cmp_gt_u32 s3, 6
s_cbranch_scc1 K2_NOINS
s_waitcnt vmcnt(0)
s_mov_b32 s52, 97792
s_mov_b32 s53, 88576
s_mov_b64 exec, s[64:65]
v_lshl_add_u32 v10, v108, 1, v124
v_lshrrev_b32 v13, 16, v57
v_mul_u32_u24 v13, 640, v13
v_lshl_add_u32 v15, v10, 2, s52
ds_write_b32 v15, v13
v_lshl_add_u32 v15, v10, 3, s53
ds_write_b64 v15, v[56:57]
s_mov_b64 exec, s[66:67]
v_lshl_add_u32 v10, v109, 1, v125
v_lshrrev_b32 v13, 16, v59
v_mul_u32_u24 v13, 640, v13
v_lshl_add_u32 v15, v10, 2, s52
ds_write_b32 v15, v13
v_lshl_add_u32 v15, v10, 3, s53
ds_write_b64 v15, v[58:59]
s_mov_b64 exec, s[68:69]
v_lshl_add_u32 v10, v110, 1, v126
v_lshrrev_b32 v13, 16, v61
v_mul_u32_u24 v13, 640, v13
v_lshl_add_u32 v15, v10, 2, s52
ds_write_b32 v15, v13
v_lshl_add_u32 v15, v10, 3, s53
ds_write_b64 v15, v[60:61]
s_mov_b64 exec, s[70:71]
v_lshl_add_u32 v10, v111, 1, v127
v_lshrrev_b32 v13, 16, v63
v_mul_u32_u24 v13, 640, v13
v_lshl_add_u32 v15, v10, 2, s52
ds_write_b32 v15, v13
v_lshl_add_u32 v15, v10, 3, s53
ds_write_b64 v15, v[62:63]
s_mov_b64 exec, -1
K2_NOINS:
v_and_b32 v8, 15, v2
v_lshlrev_b32 v8, 1, v8
v_lshrrev_b32 v12, 4, v2
v_add_u32 v8, v8, v12
v_and_b32 v7, 3, v8
v_lshlrev_b32 v7, 3, v7
v_lshrrev_b32 v12, 2, v8
v_add_u32 v7, v7, v12
v_lshlrev_b32 v7, 4, v7
v_lshlrev_b32 v8, 2, v8
s_waitcnt lgkmcnt(0)
v_readfirstlane_b32 s48, v11
s_nop 0
s_lshl_b32 s52, s48, 3
v_lshlrev_b32 v6, 2, v3
v_add_u32 v6, s52, v6
v_add_u32 v6, 97792, v6
s_barrier
v_lshrrev_b32 v10, 3, v1
v_lshlrev_b32 v10, 2, v10
s_lshl_b32 s52, s48, 3
s_add_u32 s52, s52, 97792
v_add_u32 v53, s52, v10
ds_read_b32 v124, v53
ds_read_b32 v120, v6 offset:0
ds_read_b32 v121, v6 offset:8
ds_read_b32 v122, v6 offset:16
ds_read_b32 v123, v6 offset:24
v_lshlrev_b32 v9, 3, v0
v_add_u32 v9, 88576, v9
ds_read_b64 v[116:117], v9
s_waitcnt lgkmcnt(1)
s_lshl_b32 s58, s3, 11
s_add_u32 s58, s58, 108544
v_and_b32 v10, 7, v1
v_lshlrev_b32 v10, 4, v10
v_add_u32 v54, 512, v10
v_add_u32 v10, v124, v54
s_mov_b32 m0, s58
s_nop 0
buffer_load_dwordx4 v10, s[32:35], 0 offen lds
v_add_u32 v10, v120, v7
buffer_load_dwordx4 v[36:39], v10, s[32:35], 0 offen
v_add_u32 v10, v121, v7
buffer_load_dwordx4 v[40:43], v10, s[32:35], 0 offen
v_add_u32 v10, v122, v7
buffer_load_dwordx4 v[44:47], v10, s[32:35], 0 offen
v_add_u32 v10, v123, v7
buffer_load_dwordx4 v[48:51], v10, s[32:35], 0 offen
v_mul_u32_u24 v10, 48, v2
v_add_u32 v10, 107008, v10
ds_read_b128 v[16:19], v10
ds_read_b128 v[20:23], v10 offset:16
ds_read_b128 v[24:27], v10 offset:32
v_mov_b32 v10, 105736
ds_read_b64 v[118:119], v10
s_waitcnt lgkmcnt(0)
v_readfirstlane_b32 s18, v118
v_readfirstlane_b32 s19, v119
s_nop 0
s_lshl_b32 s40, s18, 16
s_and_b32 s41, s18, s61
s_lshl_b32 s42, s19, 16
s_and_b32 s43, s19, s61
s_mov_b32 s44, 0x322bcc77
s_mov_b32 s45, 0x40490fdb
s_mov_b32 s46, 0x3e4ccccd
s_mov_b32 s47, 0x40a00000
s_add_u32 s60, s60, 64
s_lshl_b32 s59, s3, 5
v_mov_b32 v13, v0
K2_SCL:
s_cmp_ge_u32 s59, s60
s_cbranch_scc1 K2_NOSC
v_lshlrev_b32 v10, 2, v13
v_add_u32 v10, 97824, v10
ds_read_b32 v79, v10
s_waitcnt lgkmcnt(0)
v_cmp_ne_u32 s[66:67], -1, v117
v_lshlrev_b32 v62, 16, v116
v_and_b32 v63, s61, v116
v_lshlrev_b32 v64, 16, v117
v_mul_f32 v65, v62, v62
v_mul_f32 v66, v63, v63
v_mul_f32 v67, v64, v64
v_cvt_pk_bf16_f32 v68, v65, v66
v_cvt_pk_bf16_f32 v69, v67, v67
v_lshlrev_b32 v65, 16, v68
v_and_b32 v66, s61, v68
v_lshlrev_b32 v67, 16, v69
v_add_f32 v65, v65, v66
v_add_f32 v65, v65, v67
v_cvt_pk_bf16_f32 v65, v65, v65
v_lshlrev_b32 v65, 16, v65
v_add_f32 v65, s44, v65
v_cvt_pk_bf16_f32 v65, v65, v65
v_lshlrev_b32 v65, 16, v65
v_sqrt_f32 v65, v65
s_nop 0
v_cvt_pk_bf16_f32 v65, v65, v65
v_lshlrev_b32 v65, 16, v65
v_rcp_f32 v66, v65
v_mul_f32 v67, s45, v65
v_cvt_pk_bf16_f32 v67, v67, v67
v_lshlrev_b32 v67, 16, v67
v_mul_f32 v62, v62, v66
v_mul_f32 v63, v63, v66
v_mul_f32 v64, v64, v66
v_mul_f32 v67, s46, v67
v_cvt_pk_bf16_f32 v68, v62, v63
v_cvt_pk_bf16_f32 v69, v64, v67
v_lshlrev_b32 v76, 16, v68
v_and_b32 v77, s61, v68
v_lshlrev_b32 v78, 16, v69
v_and_b32 v67, s61, v69
v_mul_f32 v67, 0.15915494, v67
v_cos_f32 v67, v67
s_nop 0
v_cvt_pk_bf16_f32 v67, v67, v67
v_lshlrev_b32 v67, 16, v67
v_add_f32 v67, 1.0, v67
v_cvt_pk_bf16_f32 v67, v67, v67
v_lshlrev_b32 v67, 16, v67
v_mul_f32 v67, 0.5, v67
v_cmp_gt_f32 vcc, s47, v65
s_nop 1
v_cndmask_b32 v67, 0, v67, vcc
v_mul_f32 v68, s40, v65
v_mul_f32 v69, s41, v65
v_cvt_pk_bf16_f32 v70, v68, v69
v_lshlrev_b32 v68, 16, v70
v_and_b32 v69, s61, v70
v_mul_f32 v68, 0.15915494, v68
v_mul_f32 v69, 0.15915494, v69
v_fract_f32 v68, v68
v_fract_f32 v69, v69
v_sin_f32 v68, v68
v_sin_f32 v69, v69
s_nop 0
v_cvt_pk_bf16_f32 v70, v68, v69
v_lshlrev_b32 v68, 16, v70
v_and_b32 v69, s61, v70
v_mul_f32 v68, v68, v66
v_mul_f32 v69, v69, v66
v_cvt_pk_bf16_f32 v70, v68, v69
v_lshlrev_b32 v68, 16, v70
v_and_b32 v69, s61, v70
v_mul_f32 v68, v68, v67
v_mul_f32 v69, v69, v67
v_cvt_pk_bf16_f32 v80, v68, v69
v_lshlrev_b32 v70, 16, v80
v_and_b32 v71, s61, v80
v_sub_f32 v68, v68, v70
v_sub_f32 v69, v69, v71
v_cvt_pk_bf16_f32 v82, v68, v69
v_mul_f32 v68, s42, v65
v_mul_f32 v69, s43, v65
v_cvt_pk_bf16_f32 v70, v68, v69
v_lshlrev_b32 v68, 16, v70
v_and_b32 v69, s61, v70
v_mul_f32 v68, 0.15915494, v68
v_mul_f32 v69, 0.15915494, v69
v_fract_f32 v68, v68
v_fract_f32 v69, v69
v_sin_f32 v68, v68
v_sin_f32 v69, v69
s_nop 0
v_cvt_pk_bf16_f32 v70, v68, v69
v_lshlrev_b32 v68, 16, v70
v_and_b32 v69, s61, v70
v_mul_f32 v68, v68, v66
v_mul_f32 v69, v69, v66
v_cvt_pk_bf16_f32 v70, v68, v69
v_lshlrev_b32 v68, 16, v70
v_and_b32 v69, s61, v70
v_mul_f32 v68, v68, v67
v_mul_f32 v69, v69, v67
v_cvt_pk_bf16_f32 v81, v68, v69
v_lshlrev_b32 v70, 16, v81
v_and_b32 v71, s61, v81
v_sub_f32 v68, v68, v70
v_sub_f32 v69, v69, v71
v_cvt_pk_bf16_f32 v83, v68, v69
s_not_b64 s[64:65], s[66:67]
s_mov_b64 exec, s[64:65]
v_mov_b32 v76, 0
v_mov_b32 v77, 0
v_mov_b32 v78, 0
v_mov_b32 v80, 0
v_mov_b32 v81, 0
v_mov_b32 v82, 0
v_mov_b32 v83, 0
s_mov_b64 exec, -1
v_lshlrev_b32 v10, 4, v13
v_add_u32 v10, 51200, v10
ds_write_b128 v10, v[76:79]
ds_write_b128 v10, v[80:83] offset:18432
v_add_u32 v13, 1024, v13
s_add_u32 s59, s59, 512
s_cmp_ge_u32 s59, s60
s_cbranch_scc1 K2_NOSC
v_lshlrev_b32 v10, 3, v13
v_add_u32 v10, 88576, v10
ds_read_b64 v[116:117], v10
s_branch K2_SCL
K2_NOSC:
v_lshrrev_b32 v10, 4, v1
v_and_b32 v11, 15, v1
v_lshlrev_b32 v11, 3, v11
v_lshl_add_u32 v4, v10, 7, v11
v_add_u32 v4, 0, v4
v_lshl_add_u32 v5, v10, 8, v11
s_lshl_b32 s52, s5, 7
v_add_u32 v5, s52, v5
v_lshl_add_u32 v8, v3, 7, v8
v_add_u32 v8, s58, v8
s_mul_i32 s51, s4, 100
s_add_u32 s51, s51, s50
s_lshl_b32 s51, s51, 10
v_lshrrev_b32 v10, 1, v2
v_lshrrev_b32 v11, 2, v10
v_lshlrev_b32 v11, 1, v11
v_and_b32 v12, 1, v10
v_add_u32 v11, v11, v12
v_lshlrev_b32 v11, 1, v11
v_bfe_u32 v12, v10, 1, 1
v_add_u32 v11, v11, v12
v_lshlrev_b32 v9, 4, v11
v_lshl_add_u32 v9, v3, 3, v9
s_lshl_b32 s52, s48, 5
s_add_u32 s53, s52, 69632
v_add_u32 v9, s53, v9
v_and_b32 v10, 1, v1
v_cmp_eq_u32 vcc, 1, v10
v_mov_b32 v14, 0x0c0c0100
v_mov_b32 v15, 0x01000c0c
v_cndmask_b32 v14, v14, v15, vcc
v_mov_b32 v15, 0x0c0c0302
v_mov_b32 v10, 0x03020c0c
v_cndmask_b32 v15, v15, v10, vcc
s_lshl_b32 s53, s48, 2
s_add_u32 s53, s53, 103168
v_lshl_add_u32 v6, v1, 2, s53
s_add_u32 s52, s52, 51200
v_lshl_add_u32 v1, v3, 4, s52
v_mov_b32 v28, 0
v_mov_b32 v29, 0
v_mov_b32 v30, 0
v_mov_b32 v31, 0
v_mov_b32 v32, 0
v_mov_b32 v33, 0
v_mov_b32 v34, 0
v_mov_b32 v35, 0
v_mov_b32 v2, 0
v_mov_b32 v3, 0
s_waitcnt vmcnt(5) lgkmcnt(0)
s_barrier
s_cmp_eq_u32 s57, 0
s_cbranch_scc1 K2_DONE
ds_read_b64 v[12:13], v9
ds_read_b32 v55, v53 offset:32
K2_LOOP:
ds_read_b32 v11, v6
ds_read_b128 v[108:111], v1
s_waitcnt lgkmcnt(2)
v_perm_b32 v104, v12, v12, v14
v_perm_b32 v105, v12, v12, v15
v_perm_b32 v106, v13, v13, v14
v_perm_b32 v107, v13, v13, v15
s_nop 1
v_mfma_f32_32x32x16_bf16 v[56:71], v[104:107], v[16:19], 0
v_mfma_f32_32x32x16_bf16 v[88:103], v[104:107], v[24:27], 0
v_mfma_f32_32x32x16_bf16 v[72:87], v[104:107], v[20:23], 0
ds_read_b64 v[12:13], v9 offset:256
s_waitcnt lgkmcnt(2)
v_cmp_ne_u32 s[64:65], 0, v11
ds_read_b128 v[112:115], v1 offset:32
s_waitcnt vmcnt(3)
ds_read_b32 v52, v8 offset:0
v_add_u32 v10, v55, v54
s_add_u32 m0, s58, 1024
s_waitcnt lgkmcnt(0)
buffer_load_dwordx4 v10, s[32:35], 0 offen lds
v_add_u32 v53, 32, v53
ds_read_b32 v55, v53 offset:32
v_lshlrev_b32 v116, 16, v36
v_and_b32 v117, s61, v36
v_lshlrev_b32 v118, 16, v37
v_and_b32 v119, s61, v37
v_lshlrev_b32 v120, 16, v38
v_and_b32 v121, s61, v38
v_lshlrev_b32 v122, 16, v39
v_and_b32 v123, s61, v39
v_lshlrev_b32 v124, 16, v52
v_and_b32 v125, s61, v52
v_pk_fma_f32 v[28:29], v[116:117], v[56:57], v[28:29]
v_pk_mul_f32 v[118:119], v[118:119], v[88:89]
v_pk_fma_f32 v[30:31], v[120:121], v[72:73], v[30:31]
v_pk_fma_f32 v[32:33], v[122:123], v[72:73], v[32:33]
v_pk_fma_f32 v[34:35], v[124:125], v[72:73], v[34:35]
v_pk_fma_f32 v[30:31], v[108:109], v[118:119], v[30:31] op_sel:[0,0,0] op_sel_hi:[0,1,1]
v_pk_fma_f32 v[32:33], v[108:109], v[118:119], v[32:33] op_sel:[1,0,0] op_sel_hi:[1,1,1]
v_pk_fma_f32 v[34:35], v[110:111], v[118:119], v[34:35] op_sel:[0,0,0] op_sel_hi:[0,1,1]
v_add_u32 v10, v111, v7
buffer_load_dwordx4 v[36:39], v10, s[32:35], 0 offen
s_bitcmp0_b64 s[64:65], 0
s_cbranch_scc1 K2_NOFIN0
s_lshl_b32 s52, s50, 9
v_add_u32 v126, s52, v4
ds_read_b64 v[124:125], v126
v_permlane32_swap_b32 v28, v32
v_permlane32_swap_b32 v29, v33
v_permlane32_swap_b32 v30, v34
v_permlane32_swap_b32 v31, v35
v_pk_add_f32 v[28:29], v[28:29], v[32:33]
v_pk_add_f32 v[30:31], v[30:31], v[34:35]
s_nop 1
v_permlane16_swap_b32 v28, v30
v_permlane16_swap_b32 v29, v31
s_waitcnt lgkmcnt(0)
v_lshlrev_b32 v120, 16, v124
v_and_b32 v121, s61, v124
v_lshlrev_b32 v122, 16, v125
v_and_b32 v123, s61, v125
v_pk_add_f32 v[120:121], v[120:121], v[28:29]
v_pk_add_f32 v[122:123], v[122:123], v[30:31]
v_cvt_pk_bf16_f32 v124, v120, v121
v_cvt_pk_bf16_f32 v125, v122, v123
buffer_store_dwordx2 v[124:125], v5, s[24:27], s51 offen nt
v_pk_mul_f32 v[28:29], v[2:3], v[2:3]
v_pk_mul_f32 v[30:31], v[2:3], v[2:3]
v_pk_mul_f32 v[32:33], v[2:3], v[2:3]
v_pk_mul_f32 v[34:35], v[2:3], v[2:3]
s_add_u32 s50, s50, 1
s_add_u32 s51, s51, 1024
s_cmp_ge_u32 s50, s57
s_cbranch_scc1 K2_DONE
K2_NOFIN0:
ds_read_b128 v[108:111], v1 offset:64
s_waitcnt vmcnt(4)
ds_read_b32 v52, v8 offset:256
s_waitcnt lgkmcnt(0)
v_lshlrev_b32 v116, 16, v40
v_and_b32 v117, s61, v40
v_lshlrev_b32 v118, 16, v41
v_and_b32 v119, s61, v41
v_lshlrev_b32 v120, 16, v42
v_and_b32 v121, s61, v42
v_lshlrev_b32 v122, 16, v43
v_and_b32 v123, s61, v43
v_lshlrev_b32 v124, 16, v52
v_and_b32 v125, s61, v52
v_pk_fma_f32 v[28:29], v[116:117], v[58:59], v[28:29]
v_pk_mul_f32 v[118:119], v[118:119], v[90:91]
v_pk_fma_f32 v[30:31], v[120:121], v[74:75], v[30:31]
v_pk_fma_f32 v[32:33], v[122:123], v[74:75], v[32:33]
v_pk_fma_f32 v[34:35], v[124:125], v[74:75], v[34:35]
v_pk_fma_f32 v[30:31], v[112:113], v[118:119], v[30:31] op_sel:[0,0,0] op_sel_hi:[0,1,1]
v_pk_fma_f32 v[32:33], v[112:113], v[118:119], v[32:33] op_sel:[1,0,0] op_sel_hi:[1,1,1]
v_pk_fma_f32 v[34:35], v[114:115], v[118:119], v[34:35] op_sel:[0,0,0] op_sel_hi:[0,1,1]
v_add_u32 v10, v115, v7
buffer_load_dwordx4 v[40:43], v10, s[32:35], 0 offen
s_bitcmp0_b64 s[64:65], 1
s_cbranch_scc1 K2_NOFIN1
s_lshl_b32 s52, s50, 9
v_add_u32 v126, s52, v4
ds_read_b64 v[124:125], v126
v_permlane32_swap_b32 v28, v32
v_permlane32_swap_b32 v29, v33
v_permlane32_swap_b32 v30, v34
v_permlane32_swap_b32 v31, v35
v_pk_add_f32 v[28:29], v[28:29], v[32:33]
v_pk_add_f32 v[30:31], v[30:31], v[34:35]
s_nop 1
v_permlane16_swap_b32 v28, v30
v_permlane16_swap_b32 v29, v31
s_waitcnt lgkmcnt(0)
v_lshlrev_b32 v120, 16, v124
v_and_b32 v121, s61, v124
v_lshlrev_b32 v122, 16, v125
v_and_b32 v123, s61, v125
v_pk_add_f32 v[120:121], v[120:121], v[28:29]
v_pk_add_f32 v[122:123], v[122:123], v[30:31]
v_cvt_pk_bf16_f32 v124, v120, v121
v_cvt_pk_bf16_f32 v125, v122, v123
buffer_store_dwordx2 v[124:125], v5, s[24:27], s51 offen nt
v_pk_mul_f32 v[28:29], v[2:3], v[2:3]
v_pk_mul_f32 v[30:31], v[2:3], v[2:3]
v_pk_mul_f32 v[32:33], v[2:3], v[2:3]
v_pk_mul_f32 v[34:35], v[2:3], v[2:3]
s_add_u32 s50, s50, 1
s_add_u32 s51, s51, 1024
s_cmp_ge_u32 s50, s57
s_cbranch_scc1 K2_DONE
K2_NOFIN1:
ds_read_b128 v[112:115], v1 offset:96
s_waitcnt vmcnt(4)
ds_read_b32 v52, v8 offset:512
s_waitcnt lgkmcnt(0)
v_lshlrev_b32 v116, 16, v44
v_and_b32 v117, s61, v44
v_lshlrev_b32 v118, 16, v45
v_and_b32 v119, s61, v45
v_lshlrev_b32 v120, 16, v46
v_and_b32 v121, s61, v46
v_lshlrev_b32 v122, 16, v47
v_and_b32 v123, s61, v47
v_lshlrev_b32 v124, 16, v52
v_and_b32 v125, s61, v52
v_pk_fma_f32 v[28:29], v[116:117], v[60:61], v[28:29]
v_pk_mul_f32 v[118:119], v[118:119], v[92:93]
v_pk_fma_f32 v[30:31], v[120:121], v[76:77], v[30:31]
v_pk_fma_f32 v[32:33], v[122:123], v[76:77], v[32:33]
v_pk_fma_f32 v[34:35], v[124:125], v[76:77], v[34:35]
v_pk_fma_f32 v[30:31], v[108:109], v[118:119], v[30:31] op_sel:[0,0,0] op_sel_hi:[0,1,1]
v_pk_fma_f32 v[32:33], v[108:109], v[118:119], v[32:33] op_sel:[1,0,0] op_sel_hi:[1,1,1]
v_pk_fma_f32 v[34:35], v[110:111], v[118:119], v[34:35] op_sel:[0,0,0] op_sel_hi:[0,1,1]
v_add_u32 v10, v111, v7
buffer_load_dwordx4 v[44:47], v10, s[32:35], 0 offen
s_bitcmp0_b64 s[64:65], 2
s_cbranch_scc1 K2_NOFIN2
s_lshl_b32 s52, s50, 9
v_add_u32 v126, s52, v4
ds_read_b64 v[124:125], v126
v_permlane32_swap_b32 v28, v32
v_permlane32_swap_b32 v29, v33
v_permlane32_swap_b32 v30, v34
v_permlane32_swap_b32 v31, v35
v_pk_add_f32 v[28:29], v[28:29], v[32:33]
v_pk_add_f32 v[30:31], v[30:31], v[34:35]
s_nop 1
v_permlane16_swap_b32 v28, v30
v_permlane16_swap_b32 v29, v31
s_waitcnt lgkmcnt(0)
v_lshlrev_b32 v120, 16, v124
v_and_b32 v121, s61, v124
v_lshlrev_b32 v122, 16, v125
v_and_b32 v123, s61, v125
v_pk_add_f32 v[120:121], v[120:121], v[28:29]
v_pk_add_f32 v[122:123], v[122:123], v[30:31]
v_cvt_pk_bf16_f32 v124, v120, v121
v_cvt_pk_bf16_f32 v125, v122, v123
buffer_store_dwordx2 v[124:125], v5, s[24:27], s51 offen nt
v_pk_mul_f32 v[28:29], v[2:3], v[2:3]
v_pk_mul_f32 v[30:31], v[2:3], v[2:3]
v_pk_mul_f32 v[32:33], v[2:3], v[2:3]
v_pk_mul_f32 v[34:35], v[2:3], v[2:3]
s_add_u32 s50, s50, 1
s_add_u32 s51, s51, 1024
s_cmp_ge_u32 s50, s57
s_cbranch_scc1 K2_DONE
K2_NOFIN2:
ds_read_b128 v[108:111], v1 offset:128
s_waitcnt vmcnt(4)
ds_read_b32 v52, v8 offset:768
s_waitcnt lgkmcnt(0)
v_lshlrev_b32 v116, 16, v48
v_and_b32 v117, s61, v48
v_lshlrev_b32 v118, 16, v49
v_and_b32 v119, s61, v49
v_lshlrev_b32 v120, 16, v50
v_and_b32 v121, s61, v50
v_lshlrev_b32 v122, 16, v51
v_and_b32 v123, s61, v51
v_lshlrev_b32 v124, 16, v52
v_and_b32 v125, s61, v52
v_pk_fma_f32 v[28:29], v[116:117], v[62:63], v[28:29]
v_pk_mul_f32 v[118:119], v[118:119], v[94:95]
v_pk_fma_f32 v[30:31], v[120:121], v[78:79], v[30:31]
v_pk_fma_f32 v[32:33], v[122:123], v[78:79], v[32:33]
v_pk_fma_f32 v[34:35], v[124:125], v[78:79], v[34:35]
v_pk_fma_f32 v[30:31], v[112:113], v[118:119], v[30:31] op_sel:[0,0,0] op_sel_hi:[0,1,1]
v_pk_fma_f32 v[32:33], v[112:113], v[118:119], v[32:33] op_sel:[1,0,0] op_sel_hi:[1,1,1]
v_pk_fma_f32 v[34:35], v[114:115], v[118:119], v[34:35] op_sel:[0,0,0] op_sel_hi:[0,1,1]
v_add_u32 v10, v115, v7
buffer_load_dwordx4 v[48:51], v10, s[32:35], 0 offen
s_bitcmp0_b64 s[64:65], 3
s_cbranch_scc1 K2_NOFIN3
s_lshl_b32 s52, s50, 9
v_add_u32 v126, s52, v4
ds_read_b64 v[124:125], v126
v_permlane32_swap_b32 v28, v32
v_permlane32_swap_b32 v29, v33
v_permlane32_swap_b32 v30, v34
v_permlane32_swap_b32 v31, v35
v_pk_add_f32 v[28:29], v[28:29], v[32:33]
v_pk_add_f32 v[30:31], v[30:31], v[34:35]
s_nop 1
v_permlane16_swap_b32 v28, v30
v_permlane16_swap_b32 v29, v31
s_waitcnt lgkmcnt(0)
v_lshlrev_b32 v120, 16, v124
v_and_b32 v121, s61, v124
v_lshlrev_b32 v122, 16, v125
v_and_b32 v123, s61, v125
v_pk_add_f32 v[120:121], v[120:121], v[28:29]
v_pk_add_f32 v[122:123], v[122:123], v[30:31]
v_cvt_pk_bf16_f32 v124, v120, v121
v_cvt_pk_bf16_f32 v125, v122, v123
buffer_store_dwordx2 v[124:125], v5, s[24:27], s51 offen nt
v_pk_mul_f32 v[28:29], v[2:3], v[2:3]
v_pk_mul_f32 v[30:31], v[2:3], v[2:3]
v_pk_mul_f32 v[32:33], v[2:3], v[2:3]
v_pk_mul_f32 v[34:35], v[2:3], v[2:3]
s_add_u32 s50, s50, 1
s_add_u32 s51, s51, 1024
s_cmp_ge_u32 s50, s57
s_cbranch_scc1 K2_DONE
K2_NOFIN3:
ds_read_b128 v[112:115], v1 offset:160
s_waitcnt vmcnt(3)
ds_read_b32 v52, v8 offset:1024
v_add_u32 v10, v55, v54
s_add_u32 m0, s58, 0
s_waitcnt lgkmcnt(0)
buffer_load_dwordx4 v10, s[32:35], 0 offen lds
v_add_u32 v53, 32, v53
ds_read_b32 v55, v53 offset:32
v_lshlrev_b32 v116, 16, v36
v_and_b32 v117, s61, v36
v_lshlrev_b32 v118, 16, v37
v_and_b32 v119, s61, v37
v_lshlrev_b32 v120, 16, v38
v_and_b32 v121, s61, v38
v_lshlrev_b32 v122, 16, v39
v_and_b32 v123, s61, v39
v_lshlrev_b32 v124, 16, v52
v_and_b32 v125, s61, v52
v_pk_fma_f32 v[28:29], v[116:117], v[64:65], v[28:29]
v_pk_mul_f32 v[118:119], v[118:119], v[96:97]
v_pk_fma_f32 v[30:31], v[120:121], v[80:81], v[30:31]
v_pk_fma_f32 v[32:33], v[122:123], v[80:81], v[32:33]
v_pk_fma_f32 v[34:35], v[124:125], v[80:81], v[34:35]
v_pk_fma_f32 v[30:31], v[108:109], v[118:119], v[30:31] op_sel:[0,0,0] op_sel_hi:[0,1,1]
v_pk_fma_f32 v[32:33], v[108:109], v[118:119], v[32:33] op_sel:[1,0,0] op_sel_hi:[1,1,1]
v_pk_fma_f32 v[34:35], v[110:111], v[118:119], v[34:35] op_sel:[0,0,0] op_sel_hi:[0,1,1]
v_add_u32 v10, v111, v7
buffer_load_dwordx4 v[36:39], v10, s[32:35], 0 offen
s_bitcmp0_b64 s[64:65], 4
s_cbranch_scc1 K2_NOFIN4
s_lshl_b32 s52, s50, 9
v_add_u32 v126, s52, v4
ds_read_b64 v[124:125], v126
v_permlane32_swap_b32 v28, v32
v_permlane32_swap_b32 v29, v33
v_permlane32_swap_b32 v30, v34
v_permlane32_swap_b32 v31, v35
v_pk_add_f32 v[28:29], v[28:29], v[32:33]
v_pk_add_f32 v[30:31], v[30:31], v[34:35]
s_nop 1
v_permlane16_swap_b32 v28, v30
v_permlane16_swap_b32 v29, v31
s_waitcnt lgkmcnt(0)
v_lshlrev_b32 v120, 16, v124
v_and_b32 v121, s61, v124
v_lshlrev_b32 v122, 16, v125
v_and_b32 v123, s61, v125
v_pk_add_f32 v[120:121], v[120:121], v[28:29]
v_pk_add_f32 v[122:123], v[122:123], v[30:31]
v_cvt_pk_bf16_f32 v124, v120, v121
v_cvt_pk_bf16_f32 v125, v122, v123
buffer_store_dwordx2 v[124:125], v5, s[24:27], s51 offen nt
v_pk_mul_f32 v[28:29], v[2:3], v[2:3]
v_pk_mul_f32 v[30:31], v[2:3], v[2:3]
v_pk_mul_f32 v[32:33], v[2:3], v[2:3]
v_pk_mul_f32 v[34:35], v[2:3], v[2:3]
s_add_u32 s50, s50, 1
s_add_u32 s51, s51, 1024
s_cmp_ge_u32 s50, s57
s_cbranch_scc1 K2_DONE
K2_NOFIN4:
ds_read_b128 v[108:111], v1 offset:192
s_waitcnt vmcnt(4)
ds_read_b32 v52, v8 offset:1280
s_waitcnt lgkmcnt(0)
v_lshlrev_b32 v116, 16, v40
v_and_b32 v117, s61, v40
v_lshlrev_b32 v118, 16, v41
v_and_b32 v119, s61, v41
v_lshlrev_b32 v120, 16, v42
v_and_b32 v121, s61, v42
v_lshlrev_b32 v122, 16, v43
v_and_b32 v123, s61, v43
v_lshlrev_b32 v124, 16, v52
v_and_b32 v125, s61, v52
v_pk_fma_f32 v[28:29], v[116:117], v[66:67], v[28:29]
v_pk_mul_f32 v[118:119], v[118:119], v[98:99]
v_pk_fma_f32 v[30:31], v[120:121], v[82:83], v[30:31]
v_pk_fma_f32 v[32:33], v[122:123], v[82:83], v[32:33]
v_pk_fma_f32 v[34:35], v[124:125], v[82:83], v[34:35]
v_pk_fma_f32 v[30:31], v[112:113], v[118:119], v[30:31] op_sel:[0,0,0] op_sel_hi:[0,1,1]
v_pk_fma_f32 v[32:33], v[112:113], v[118:119], v[32:33] op_sel:[1,0,0] op_sel_hi:[1,1,1]
v_pk_fma_f32 v[34:35], v[114:115], v[118:119], v[34:35] op_sel:[0,0,0] op_sel_hi:[0,1,1]
v_add_u32 v10, v115, v7
buffer_load_dwordx4 v[40:43], v10, s[32:35], 0 offen
s_bitcmp0_b64 s[64:65], 5
s_cbranch_scc1 K2_NOFIN5
s_lshl_b32 s52, s50, 9
v_add_u32 v126, s52, v4
ds_read_b64 v[124:125], v126
v_permlane32_swap_b32 v28, v32
v_permlane32_swap_b32 v29, v33
v_permlane32_swap_b32 v30, v34
v_permlane32_swap_b32 v31, v35
v_pk_add_f32 v[28:29], v[28:29], v[32:33]
v_pk_add_f32 v[30:31], v[30:31], v[34:35]
s_nop 1
v_permlane16_swap_b32 v28, v30
v_permlane16_swap_b32 v29, v31
s_waitcnt lgkmcnt(0)
v_lshlrev_b32 v120, 16, v124
v_and_b32 v121, s61, v124
v_lshlrev_b32 v122, 16, v125
v_and_b32 v123, s61, v125
v_pk_add_f32 v[120:121], v[120:121], v[28:29]
v_pk_add_f32 v[122:123], v[122:123], v[30:31]
v_cvt_pk_bf16_f32 v124, v120, v121
v_cvt_pk_bf16_f32 v125, v122, v123
buffer_store_dwordx2 v[124:125], v5, s[24:27], s51 offen nt
v_pk_mul_f32 v[28:29], v[2:3], v[2:3]
v_pk_mul_f32 v[30:31], v[2:3], v[2:3]
v_pk_mul_f32 v[32:33], v[2:3], v[2:3]
v_pk_mul_f32 v[34:35], v[2:3], v[2:3]
s_add_u32 s50, s50, 1
s_add_u32 s51, s51, 1024
s_cmp_ge_u32 s50, s57
s_cbranch_scc1 K2_DONE
K2_NOFIN5:
ds_read_b128 v[112:115], v1 offset:224
s_waitcnt vmcnt(4)
ds_read_b32 v52, v8 offset:1536
s_waitcnt lgkmcnt(0)
v_lshlrev_b32 v116, 16, v44
v_and_b32 v117, s61, v44
v_lshlrev_b32 v118, 16, v45
v_and_b32 v119, s61, v45
v_lshlrev_b32 v120, 16, v46
v_and_b32 v121, s61, v46
v_lshlrev_b32 v122, 16, v47
v_and_b32 v123, s61, v47
v_lshlrev_b32 v124, 16, v52
v_and_b32 v125, s61, v52
v_pk_fma_f32 v[28:29], v[116:117], v[68:69], v[28:29]
v_pk_mul_f32 v[118:119], v[118:119], v[100:101]
v_pk_fma_f32 v[30:31], v[120:121], v[84:85], v[30:31]
v_pk_fma_f32 v[32:33], v[122:123], v[84:85], v[32:33]
v_pk_fma_f32 v[34:35], v[124:125], v[84:85], v[34:35]
v_pk_fma_f32 v[30:31], v[108:109], v[118:119], v[30:31] op_sel:[0,0,0] op_sel_hi:[0,1,1]
v_pk_fma_f32 v[32:33], v[108:109], v[118:119], v[32:33] op_sel:[1,0,0] op_sel_hi:[1,1,1]
v_pk_fma_f32 v[34:35], v[110:111], v[118:119], v[34:35] op_sel:[0,0,0] op_sel_hi:[0,1,1]
v_add_u32 v10, v111, v7
buffer_load_dwordx4 v[44:47], v10, s[32:35], 0 offen
s_bitcmp0_b64 s[64:65], 6
s_cbranch_scc1 K2_NOFIN6
s_lshl_b32 s52, s50, 9
v_add_u32 v126, s52, v4
ds_read_b64 v[124:125], v126
v_permlane32_swap_b32 v28, v32
v_permlane32_swap_b32 v29, v33
v_permlane32_swap_b32 v30, v34
v_permlane32_swap_b32 v31, v35
v_pk_add_f32 v[28:29], v[28:29], v[32:33]
v_pk_add_f32 v[30:31], v[30:31], v[34:35]
s_nop 1
v_permlane16_swap_b32 v28, v30
v_permlane16_swap_b32 v29, v31
s_waitcnt lgkmcnt(0)
v_lshlrev_b32 v120, 16, v124
v_and_b32 v121, s61, v124
v_lshlrev_b32 v122, 16, v125
v_and_b32 v123, s61, v125
v_pk_add_f32 v[120:121], v[120:121], v[28:29]
v_pk_add_f32 v[122:123], v[122:123], v[30:31]
v_cvt_pk_bf16_f32 v124, v120, v121
v_cvt_pk_bf16_f32 v125, v122, v123
buffer_store_dwordx2 v[124:125], v5, s[24:27], s51 offen nt
v_pk_mul_f32 v[28:29], v[2:3], v[2:3]
v_pk_mul_f32 v[30:31], v[2:3], v[2:3]
v_pk_mul_f32 v[32:33], v[2:3], v[2:3]
v_pk_mul_f32 v[34:35], v[2:3], v[2:3]
s_add_u32 s50, s50, 1
s_add_u32 s51, s51, 1024
s_cmp_ge_u32 s50, s57
s_cbranch_scc1 K2_DONE
K2_NOFIN6:
s_waitcnt vmcnt(4)
ds_read_b32 v52, v8 offset:1792
s_waitcnt lgkmcnt(0)
v_lshlrev_b32 v116, 16, v48
v_and_b32 v117, s61, v48
v_lshlrev_b32 v118, 16, v49
v_and_b32 v119, s61, v49
v_lshlrev_b32 v120, 16, v50
v_and_b32 v121, s61, v50
v_lshlrev_b32 v122, 16, v51
v_and_b32 v123, s61, v51
v_lshlrev_b32 v124, 16, v52
v_and_b32 v125, s61, v52
v_pk_fma_f32 v[28:29], v[116:117], v[70:71], v[28:29]
v_pk_mul_f32 v[118:119], v[118:119], v[102:103]
v_pk_fma_f32 v[30:31], v[120:121], v[86:87], v[30:31]
v_pk_fma_f32 v[32:33], v[122:123], v[86:87], v[32:33]
v_pk_fma_f32 v[34:35], v[124:125], v[86:87], v[34:35]
v_pk_fma_f32 v[30:31], v[112:113], v[118:119], v[30:31] op_sel:[0,0,0] op_sel_hi:[0,1,1]
v_pk_fma_f32 v[32:33], v[112:113], v[118:119], v[32:33] op_sel:[1,0,0] op_sel_hi:[1,1,1]
v_pk_fma_f32 v[34:35], v[114:115], v[118:119], v[34:35] op_sel:[0,0,0] op_sel_hi:[0,1,1]
v_add_u32 v10, v115, v7
buffer_load_dwordx4 v[48:51], v10, s[32:35], 0 offen
s_bitcmp0_b64 s[64:65], 7
s_cbranch_scc1 K2_NOFIN7
s_lshl_b32 s52, s50, 9
v_add_u32 v126, s52, v4
ds_read_b64 v[124:125], v126
v_permlane32_swap_b32 v28, v32
v_permlane32_swap_b32 v29, v33
v_permlane32_swap_b32 v30, v34
v_permlane32_swap_b32 v31, v35
v_pk_add_f32 v[28:29], v[28:29], v[32:33]
v_pk_add_f32 v[30:31], v[30:31], v[34:35]
s_nop 1
v_permlane16_swap_b32 v28, v30
v_permlane16_swap_b32 v29, v31
s_waitcnt lgkmcnt(0)
v_lshlrev_b32 v120, 16, v124
v_and_b32 v121, s61, v124
v_lshlrev_b32 v122, 16, v125
v_and_b32 v123, s61, v125
v_pk_add_f32 v[120:121], v[120:121], v[28:29]
v_pk_add_f32 v[122:123], v[122:123], v[30:31]
v_cvt_pk_bf16_f32 v124, v120, v121
v_cvt_pk_bf16_f32 v125, v122, v123
buffer_store_dwordx2 v[124:125], v5, s[24:27], s51 offen nt
v_pk_mul_f32 v[28:29], v[2:3], v[2:3]
v_pk_mul_f32 v[30:31], v[2:3], v[2:3]
v_pk_mul_f32 v[32:33], v[2:3], v[2:3]
v_pk_mul_f32 v[34:35], v[2:3], v[2:3]
s_add_u32 s50, s50, 1
s_add_u32 s51, s51, 1024
s_cmp_ge_u32 s50, s57
s_cbranch_scc1 K2_DONE
K2_NOFIN7:
v_add_u32 v9, 256, v9
v_add_u32 v1, 256, v1
v_add_u32 v6, 32, v6
s_branch K2_LOOP
K2_SLOW:
s_waitcnt vmcnt(0) lgkmcnt(0)
s_barrier
v_mov_b32 v10, 105736
ds_read_b64 v[118:119], v10
s_waitcnt lgkmcnt(0)
v_readfirstlane_b32 s18, v118
v_readfirstlane_b32 s19, v119
s_load_dwordx2 s[10:11], s[0:1], 8
s_load_dwordx4 s[12:15], s[0:1], 16
s_mov_b32 s61, 0xffff0000
s_lshl_b32 s40, s18, 16
s_and_b32 s41, s18, s61
s_lshl_b32 s42, s19, 16
s_and_b32 s43, s19, s61
s_mov_b32 s44, 0x322bcc77
s_mov_b32 s45, 0x40490fdb
s_mov_b32 s46, 0x3e4ccccd
s_mov_b32 s47, 0x40a00000
v_and_b32 v8, 15, v2
v_lshlrev_b32 v8, 1, v8
v_lshrrev_b32 v11, 4, v2
v_add_u32 v8, v8, v11
v_and_b32 v7, 3, v8
v_lshlrev_b32 v7, 3, v7
v_lshrrev_b32 v11, 2, v8
v_add_u32 v7, v7, v11
v_lshlrev_b32 v7, 4, v7
v_lshlrev_b32 v8, 2, v8
v_lshrrev_b32 v10, 4, v1
v_and_b32 v11, 15, v1
v_lshlrev_b32 v11, 3, v11
v_lshl_add_u32 v4, v10, 7, v11
v_add_u32 v4, 0, v4
v_lshl_add_u32 v5, v10, 8, v11
s_lshl_b32 s52, s5, 7
v_add_u32 v5, s52, v5
v_mul_u32_u24 v10, 48, v2
v_add_u32 v10, 107008, v10
ds_read_b128 v[16:19], v10
ds_read_b128 v[20:23], v10 offset:16
ds_read_b128 v[24:27], v10 offset:32
v_lshlrev_b32 v9, 2, v1
s_waitcnt lgkmcnt(0)
s_mov_b32 s28, s10
s_mov_b32 s29, s11
s_mov_b32 s30, 75000
s_mov_b32 s31, 0x20000
s_mov_b32 s36, s12
s_mov_b32 s37, s13
s_mov_b32 s38, 1600000
s_mov_b32 s39, 0x20000
s_mov_b32 s72, s14
s_mov_b32 s73, s15
s_mov_b32 s74, 1600000
s_mov_b32 s75, 0x20000
v_lshlrev_b32 v64, 16, v16
v_and_b32 v65, s61, v16
v_lshlrev_b32 v66, 16, v17
v_and_b32 v67, s61, v17
v_lshlrev_b32 v68, 16, v18
v_and_b32 v69, s61, v18
v_lshlrev_b32 v70, 16, v19
v_and_b32 v71, s61, v19
v_lshlrev_b32 v72, 16, v20
v_and_b32 v73, s61, v20
v_lshlrev_b32 v74, 16, v21
v_and_b32 v75, s61, v21
v_lshlrev_b32 v76, 16, v22
v_and_b32 v77, s61, v22
v_lshlrev_b32 v78, 16, v23
v_and_b32 v79, s61, v23
v_lshlrev_b32 v80, 16, v24
v_and_b32 v81, s61, v24
v_lshlrev_b32 v82, 16, v25
v_and_b32 v83, s61, v25
v_lshlrev_b32 v84, 16, v26
v_and_b32 v85, s61, v26
v_lshlrev_b32 v86, 16, v27
v_and_b32 v87, s61, v27
s_mov_b32 s56, s3
K2_SN:
s_cmp_ge_u32 s56, 100
s_cbranch_scc1 K2_DONE
s_mul_i32 s54, s4, 100
s_add_u32 s54, s54, s56
s_mul_i32 s52, s54, 6
s_and_b32 s53, s52, -4
v_mov_b32 v10, s53
buffer_load_dwordx2 v[96:97], v10, s[28:31], 0 offen
v_mov_b32 v28, 0
v_mov_b32 v29, 0
v_mov_b32 v30, 0
v_mov_b32 v31, 0
v_mov_b32 v32, 0
v_mov_b32 v33, 0
v_mov_b32 v34, 0
v_mov_b32 v35, 0
s_and_b32 s53, s54, 1
s_lshl_b32 s53, s53, 4
s_waitcnt vmcnt(0)
v_alignbit_b32 v98, v97, v96, s53
v_lshrrev_b32 v99, s53, v97
v_lshlrev_b32 v100, 16, v98
v_and_b32 v101, s61, v98
v_lshlrev_b32 v102, 16, v99
s_mov_b32 s55, 0
K2_SE:
buffer_load_dword v96, v9, s[72:75], s55 offen
buffer_load_dword v97, v9, s[36:39], s55 offen
s_waitcnt vmcnt(0)
v_cmp_eq_u32 s[58:59], s54, v96
K2_SM:
s_nop 0
s_cmp_eq_u64 s[58:59], 0
s_cbranch_scc1 K2_SEN
s_ff1_i32_b64 s57, s[58:59]
s_bitset0_b64 s[58:59], s57
s_nop 3
v_readlane_b32 s62, v97, s57
s_nop 3
s_mul_i32 s52, s62, 6
s_and_b32 s53, s52, -4
v_mov_b32 v10, s53
buffer_load_dwordx2 v[104:105], v10, s[28:31], 0 offen
s_mul_i32 s63, s62, 640
v_add_u32 v10, s63, v7
v_add_u32 v11, s63, v8
buffer_load_dwordx4 v[36:39], v10, s[32:35], 0 offen
buffer_load_dword v52, v11, s[32:35], 0 offen offset:512
s_and_b32 s53, s62, 1
s_lshl_b32 s53, s53, 4
s_waitcnt vmcnt(2)
v_alignbit_b32 v106, v105, v104, s53
v_lshrrev_b32 v107, s53, v105
v_lshlrev_b32 v108, 16, v106
v_and_b32 v109, s61, v106
v_lshlrev_b32 v110, 16, v107
v_sub_f32 v108, v108, v100
v_sub_f32 v109, v109, v101
v_sub_f32 v110, v110, v102
v_cvt_pk_bf16_f32 v106, v108, v109
v_cvt_pk_bf16_f32 v107, v110, v110
v_lshlrev_b32 v40, 16, v106
v_and_b32 v41, s61, v106
v_lshlrev_b32 v42, 16, v107
v_mul_f32 v43, v40, v40
v_mul_f32 v44, v41, v41
v_mul_f32 v45, v42, v42
v_cvt_pk_bf16_f32 v46, v43, v44
v_cvt_pk_bf16_f32 v47, v45, v45
v_lshlrev_b32 v43, 16, v46
v_and_b32 v44, s61, v46
v_lshlrev_b32 v45, 16, v47
v_add_f32 v43, v43, v44
v_add_f32 v43, v43, v45
v_cvt_pk_bf16_f32 v43, v43, v43
v_lshlrev_b32 v43, 16, v43
v_add_f32 v43, s44, v43
v_cvt_pk_bf16_f32 v43, v43, v43
v_lshlrev_b32 v43, 16, v43
v_sqrt_f32 v43, v43
s_nop 0
v_cvt_pk_bf16_f32 v43, v43, v43
v_lshlrev_b32 v43, 16, v43
v_rcp_f32 v44, v43
v_mul_f32 v45, s45, v43
v_cvt_pk_bf16_f32 v45, v45, v45
v_lshlrev_b32 v45, 16, v45
v_mul_f32 v40, v40, v44
v_mul_f32 v41, v41, v44
v_mul_f32 v42, v42, v44
v_mul_f32 v45, s46, v45
v_cvt_pk_bf16_f32 v46, v40, v41
v_cvt_pk_bf16_f32 v47, v42, v45
v_lshlrev_b32 v112, 16, v46
v_and_b32 v113, s61, v46
v_lshlrev_b32 v114, 16, v47
v_and_b32 v45, s61, v47
v_mul_f32 v45, 0.15915494, v45
v_cos_f32 v45, v45
s_nop 0
v_cvt_pk_bf16_f32 v45, v45, v45
v_lshlrev_b32 v45, 16, v45
v_add_f32 v45, 1.0, v45
v_cvt_pk_bf16_f32 v45, v45, v45
v_lshlrev_b32 v45, 16, v45
v_mul_f32 v45, 0.5, v45
v_cmp_gt_f32 vcc, s47, v43
s_nop 1
v_cndmask_b32 v45, 0, v45, vcc
v_mul_f32 v46, s40, v43
v_mul_f32 v47, s41, v43
v_cvt_pk_bf16_f32 v48, v46, v47
v_lshlrev_b32 v46, 16, v48
v_and_b32 v47, s61, v48
v_mul_f32 v46, 0.15915494, v46
v_mul_f32 v47, 0.15915494, v47
v_fract_f32 v46, v46
v_fract_f32 v47, v47
v_sin_f32 v46, v46
v_sin_f32 v47, v47
s_nop 0
v_cvt_pk_bf16_f32 v48, v46, v47
v_lshlrev_b32 v46, 16, v48
v_and_b32 v47, s61, v48
v_mul_f32 v46, v46, v44
v_mul_f32 v47, v47, v44
v_cvt_pk_bf16_f32 v48, v46, v47
v_lshlrev_b32 v46, 16, v48
v_and_b32 v47, s61, v48
v_mul_f32 v46, v46, v45
v_mul_f32 v47, v47, v45
v_cvt_pk_bf16_f32 v116, v46, v47
v_lshlrev_b32 v48, 16, v116
v_and_b32 v49, s61, v116
v_sub_f32 v46, v46, v48
v_sub_f32 v47, v47, v49
v_cvt_pk_bf16_f32 v118, v46, v47
v_mul_f32 v46, s42, v43
v_mul_f32 v47, s43, v43
v_cvt_pk_bf16_f32 v48, v46, v47
v_lshlrev_b32 v46, 16, v48
v_and_b32 v47, s61, v48
v_mul_f32 v46, 0.15915494, v46
v_mul_f32 v47, 0.15915494, v47
v_fract_f32 v46, v46
v_fract_f32 v47, v47
v_sin_f32 v46, v46
v_sin_f32 v47, v47
s_nop 0
v_cvt_pk_bf16_f32 v48, v46, v47
v_lshlrev_b32 v46, 16, v48
v_and_b32 v47, s61, v48
v_mul_f32 v46, v46, v44
v_mul_f32 v47, v47, v44
v_cvt_pk_bf16_f32 v48, v46, v47
v_lshlrev_b32 v46, 16, v48
v_and_b32 v47, s61, v48
v_mul_f32 v46, v46, v45
v_mul_f32 v47, v47, v45
v_cvt_pk_bf16_f32 v117, v46, v47
v_lshlrev_b32 v48, 16, v117
v_and_b32 v49, s61, v117
v_sub_f32 v46, v46, v48
v_sub_f32 v47, v47, v49
v_cvt_pk_bf16_f32 v119, v46, v47
v_lshlrev_b32 v88, 16, v116
v_and_b32 v89, s61, v116
v_lshlrev_b32 v90, 16, v117
v_and_b32 v91, s61, v117
v_lshlrev_b32 v92, 16, v118
v_and_b32 v93, s61, v118
v_lshlrev_b32 v94, 16, v119
v_and_b32 v95, s61, v119
v_add_f32 v88, v88, v92
v_add_f32 v89, v89, v93
v_add_f32 v90, v90, v94
v_add_f32 v91, v91, v95
v_cmp_eq_u32 vcc, 0, v3
s_nop 1
v_cndmask_b32 v88, 0, v88, vcc
v_cndmask_b32 v89, 0, v89, vcc
v_cndmask_b32 v90, 0, v90, vcc
v_cndmask_b32 v91, 0, v91, vcc
s_waitcnt vmcnt(0)
v_pk_mul_f32 v[56:57], v[88:89], v[64:65] op_sel:[0,0] op_sel_hi:[0,1]
v_pk_fma_f32 v[56:57], v[88:89], v[66:67], v[56:57] op_sel:[1,0,0] op_sel_hi:[1,1,1]
v_pk_fma_f32 v[56:57], v[90:91], v[68:69], v[56:57] op_sel:[0,0,0] op_sel_hi:[0,1,1]
v_pk_fma_f32 v[56:57], v[90:91], v[70:71], v[56:57] op_sel:[1,0,0] op_sel_hi:[1,1,1]
v_pk_mul_f32 v[58:59], v[88:89], v[72:73] op_sel:[0,0] op_sel_hi:[0,1]
v_pk_fma_f32 v[58:59], v[88:89], v[74:75], v[58:59] op_sel:[1,0,0] op_sel_hi:[1,1,1]
v_pk_fma_f32 v[58:59], v[90:91], v[76:77], v[58:59] op_sel:[0,0,0] op_sel_hi:[0,1,1]
v_pk_fma_f32 v[58:59], v[90:91], v[78:79], v[58:59] op_sel:[1,0,0] op_sel_hi:[1,1,1]
v_pk_mul_f32 v[60:61], v[88:89], v[80:81] op_sel:[0,0] op_sel_hi:[0,1]
v_pk_fma_f32 v[60:61], v[88:89], v[82:83], v[60:61] op_sel:[1,0,0] op_sel_hi:[1,1,1]
v_pk_fma_f32 v[60:61], v[90:91], v[84:85], v[60:61] op_sel:[0,0,0] op_sel_hi:[0,1,1]
v_pk_fma_f32 v[60:61], v[90:91], v[86:87], v[60:61] op_sel:[1,0,0] op_sel_hi:[1,1,1]
v_lshlrev_b32 v116, 16, v36
v_and_b32 v117, s61, v36
v_lshlrev_b32 v118, 16, v37
v_and_b32 v119, s61, v37
v_lshlrev_b32 v120, 16, v38
v_and_b32 v121, s61, v38
v_lshlrev_b32 v122, 16, v39
v_and_b32 v123, s61, v39
v_lshlrev_b32 v124, 16, v52
v_and_b32 v125, s61, v52
v_pk_fma_f32 v[28:29], v[116:117], v[56:57], v[28:29]
v_pk_mul_f32 v[118:119], v[118:119], v[60:61]
v_pk_fma_f32 v[30:31], v[120:121], v[58:59], v[30:31]
v_pk_fma_f32 v[32:33], v[122:123], v[58:59], v[32:33]
v_pk_fma_f32 v[34:35], v[124:125], v[58:59], v[34:35]
v_pk_fma_f32 v[30:31], v[112:113], v[118:119], v[30:31] op_sel:[0,0,0] op_sel_hi:[0,1,1]
v_pk_fma_f32 v[32:33], v[112:113], v[118:119], v[32:33] op_sel:[1,0,0] op_sel_hi:[1,1,1]
v_pk_fma_f32 v[34:35], v[114:115], v[118:119], v[34:35] op_sel:[0,0,0] op_sel_hi:[0,1,1]
s_branch K2_SM
K2_SEN:
s_add_u32 s55, s55, 256
s_cmp_lt_u32 s55, 1600000
s_cbranch_scc1 K2_SE
s_mov_b32 s50, s56
s_lshl_b32 s51, s54, 10
s_lshl_b32 s52, s50, 9
v_add_u32 v126, s52, v4
ds_read_b64 v[124:125], v126
v_permlane32_swap_b32 v28, v32
v_permlane32_swap_b32 v29, v33
v_permlane32_swap_b32 v30, v34
v_permlane32_swap_b32 v31, v35
v_pk_add_f32 v[28:29], v[28:29], v[32:33]
v_pk_add_f32 v[30:31], v[30:31], v[34:35]
s_nop 1
v_permlane16_swap_b32 v28, v30
v_permlane16_swap_b32 v29, v31
s_waitcnt lgkmcnt(0)
v_lshlrev_b32 v120, 16, v124
v_and_b32 v121, s61, v124
v_lshlrev_b32 v122, 16, v125
v_and_b32 v123, s61, v125
v_pk_add_f32 v[120:121], v[120:121], v[28:29]
v_pk_add_f32 v[122:123], v[122:123], v[30:31]
v_cvt_pk_bf16_f32 v124, v120, v121
v_cvt_pk_bf16_f32 v125, v122, v123
buffer_store_dwordx2 v[124:125], v5, s[24:27], s51 offen nt
v_mov_b32 v28, 0
v_mov_b32 v29, 0
v_mov_b32 v30, 0
v_mov_b32 v31, 0
v_mov_b32 v32, 0
v_mov_b32 v33, 0
v_mov_b32 v34, 0
v_mov_b32 v35, 0
s_add_u32 s50, s50, 1
s_add_u32 s51, s51, 1024
s_add_u32 s56, s56, 16
s_branch K2_SN
K2_DONE:
K2_END:
s_endpgm
.section .rodata,"a"
.p2align 6
.amdhsa_kernel painn_k1_kernel
  .amdhsa_next_free_vgpr 256
  .amdhsa_next_free_sgpr 102
  .amdhsa_accum_offset 256
  .amdhsa_group_segment_fixed_size 0
  .amdhsa_kernarg_size 88
  .amdhsa_user_sgpr_count 2
  .amdhsa_user_sgpr_kernarg_segment_ptr 1
  .amdhsa_system_sgpr_workgroup_id_x 1
.end_amdhsa_kernel
.p2align 6
.amdhsa_kernel painn_k2_kernel
  .amdhsa_next_free_vgpr 128
  .amdhsa_next_free_sgpr 102
  .amdhsa_accum_offset 128
  .amdhsa_group_segment_fixed_size 0
  .amdhsa_kernarg_size 88
  .amdhsa_user_sgpr_count 2
  .amdhsa_user_sgpr_kernarg_segment_ptr 1
  .amdhsa_system_sgpr_workgroup_id_x 1
.end_amdhsa_kernel
```
